```python
import torch

def _softmax(x, axis=-1):
    return torch.softmax(x, dim=axis)
def _gelu(x):
    return torch.nn.functional.gelu(x, approximate="tanh")
def _silu(x):
    return torch.nn.functional.silu(x)
def _sigmoid(x):
    return torch.sigmoid(x)
def _layernorm(x, axis=-1, eps=1e-5):
    m = x.mean(dim=axis, keepdim=True)
    v = x.var(dim=axis, keepdim=True, unbiased=False)
    return (x - m) / torch.sqrt(v + eps)
def _scatter_add(tgt, idx, src, axis=0):
    return tgt.clone().index_add_(axis, idx, src)
def _segment_sum(src, seg, n):
    out = torch.zeros((n,) + src.shape[1:], dtype=src.dtype)
    return out.index_add_(0, seg, src)
def _pad(x, pw):
    flat = tuple(v for pair in reversed(pw) for v in pair)
    return torch.nn.functional.pad(x, flat)

kernel_name = 'recurrent_scan__ssm_conv_s4__dense_activation_mish__prompt'

def setup_inputs():

    _w = (lambda a: (lambda t: t.to(torch.bfloat16) if t.is_floating_point() else t)(torch.as_tensor(a)))
    def _A_setup():
        B, L, D, N = 1, 2048, 640, 128
        A_re = -(lambda _x: torch.exp(torch.as_tensor(_x)))((lambda *s: torch.randn(*s, dtype=torch.bfloat16) * 3.2)(D, N))
        A_im = torch.pi * (lambda *s: torch.randn(*s, dtype=torch.bfloat16) * 0.2)(D, N)
        B_re = (lambda *s: torch.randn(*s, dtype=torch.bfloat16) * 0.2)(D, N)
        B_im = (lambda *s: torch.randn(*s, dtype=torch.bfloat16) * 0.2)(D, N)
        C_re = (lambda *s: torch.randn(*s, dtype=torch.bfloat16) * 0.2)(D, N)
        C_im = (lambda *s: torch.randn(*s, dtype=torch.bfloat16) * 0.2)(D, N)
        log_dt = (lambda *s: torch.randn(*s, dtype=torch.bfloat16) * 0.2)(D) * 0.5 - 4.0
        Dskip = (lambda *s: torch.randn(*s, dtype=torch.bfloat16) * 0.2)(D)
        return {
            "u": _w((lambda *s: torch.randn(*s, dtype=torch.bfloat16) * 0.05)(B, L, D)),
            "A_re": _w(A_re),
            "A_im": _w(A_im),
            "B_re": _w(B_re),
            "B_im": _w(B_im),
            "C_re": _w(C_re),
            "C_im": _w(C_im),
            "log_dt": _w(log_dt),
            "Dskip": _w(Dskip),
        }
    _A_in = _A_setup()

    def _B_setup():
        B, S, D, F = 1, 2048, 640, 1728
        return {
            "x": _w((lambda *s: torch.randn(*s, dtype=torch.bfloat16) * 0.05)(B, S, D)),
            "w1": _w((lambda *s: torch.randn(*s, dtype=torch.bfloat16) * 0.8)(D, F) * (D ** -0.5)),
            "b1": _w((lambda *s: torch.randn(*s, dtype=torch.bfloat16) * 0.4)(F)),
            "w2": _w((lambda *s: torch.randn(*s, dtype=torch.bfloat16) * 0.1)(F, D) * (F ** -0.5)),
        }
    _B_in = _B_setup()

    return {
        "A_u": _A_in["u"],
        "A_A_re": _A_in["A_re"],
        "A_A_im": _A_in["A_im"],
        "A_B_re": _A_in["B_re"],
        "A_B_im": _A_in["B_im"],
        "A_C_re": _A_in["C_re"],
        "A_C_im": _A_in["C_im"],
        "A_log_dt": _A_in["log_dt"],
        "A_Dskip": _A_in["Dskip"],
        "B_x": _B_in["x"],
        "B_w1": _B_in["w1"],
        "B_b1": _B_in["b1"],
        "B_w2": _B_in["w2"],
    }

def reference(A_u, A_A_re, A_A_im, A_B_re, A_B_im, A_C_re, A_C_im, A_log_dt, A_Dskip, B_x, B_w1, B_b1, B_w2):
    def _A_ref(u, A_re, A_im, B_re, B_im, C_re, C_im, log_dt, Dskip):
        Bsz, L, D = u.shape
        dt = torch.exp(log_dt)[:, None]
        A = A_re + 1j * A_im
        Bc = B_re + 1j * B_im
        Cc = C_re + 1j * C_im
        logdA = dt * A
        dB = dt * Bc
        l = (lambda x, dt: x.to(dt))(torch.arange(L), A_re.dtype)
        P = torch.exp(logdA[:, :, None] * l[None, None, :])
        K = torch.einsum("dn,dnl,dn->dl", Cc, P, dB).real
        L2 = 2 * L
        Kp = _pad(K, ((0, 0), (0, L)))
        up = (lambda x, *d: x.permute(*d))(u, 0, 2, 1)
        up = _pad(up, ((0, 0), (0, 0), (0, L)))
        Kf = (lambda x, axes=(-2,-1): torch.fft.rfft2(x.float(), dim=axes))(Kp[:, None, :], axes=(-2, -1))
        Uf = (lambda x, axes=(-2,-1): torch.fft.rfft2(x.float(), dim=axes))(up[:, :, None, :], axes=(-2, -1))
        Yf = Uf * Kf[None, :, :, :]
        y = (lambda x, s, axes=(-2,-1): torch.fft.irfft2(x, s=s, dim=axes).to(torch.bfloat16))(Yf, (1, L2), axes=(-2, -1))[:, :, 0, :L]
        y = (lambda x, *d: x.permute(*d))(y, 0, 2, 1) + u * Dskip[None, None, :]
        return y

    def _B_ref(x, w1, b1, w2):
        h = torch.einsum("bsd,df->bsf", x, w1) + b1
        sp = torch.log1p(torch.exp(-torch.abs(h))) + torch.where(h > 0, h, torch.zeros_like(h))
        act = h * torch.tanh(sp)
        return torch.einsum("bsf,fd->bsd", act, w2)

    x = A_u
    xn = _layernorm(x, axis=-1)
    s = _A_ref(xn, A_A_re, A_A_im, A_B_re, A_B_im, A_C_re, A_C_im, A_log_dt, A_Dskip)
    g = _silu(_B_ref(xn, B_w1, B_b1, B_w2))
    return x + s * g
```

```asm
; @launch kernel=l1_kernel grid=(512,1,1) block=(256,1,1) lds=65536
; @launch kernel=l2_kernel grid=(416,1,1) block=(256,1,1) lds=73728
.amdgcn_target "amdgcn-amd-amdhsa--gfx950"
.text
.p2align 8
code_start:
.globl l1_kernel
.p2align 8
.type l1_kernel,@function
l1_kernel:
  s_load_dwordx16 s[16:31], s[0:1], 0
  s_load_dwordx16 s[32:47], s[0:1], 64
  s_cmp_lt_u32 s2, 224
  s_cbranch_scc1 l1_kernel_r0
  s_cmp_lt_u32 s2, 256
  s_cbranch_scc1 l1_kernel_r1
  s_cmp_lt_u32 s2, 288
  s_cbranch_scc1 l1_kernel_r2
  s_cmp_lt_u32 s2, 384
  s_cbranch_scc1 l1_kernel_r3
  s_cmp_lt_u32 s2, 438
  s_cbranch_scc1 l1_kernel_r4
  s_cmp_lt_u32 s2, 480
  s_cbranch_scc1 l1_kernel_r5
  s_cmp_lt_u32 s2, 512
  s_cbranch_scc1 l1_kernel_r6
  s_endpgm
l1_kernel_r0:
  s_sub_u32 s3, s2, 0
  s_waitcnt lgkmcnt(0)
  s_mov_b32 s48, s18
  s_mov_b32 s49, s19
  s_mov_b32 s50, 163840
  s_mov_b32 s51, 0x20000
  s_mov_b32 s52, s20
  s_mov_b32 s53, s21
  s_mov_b32 s54, 163840
  s_mov_b32 s55, 0x20000
  s_mov_b32 s56, s22
  s_mov_b32 s57, s23
  s_mov_b32 s58, 163840
  s_mov_b32 s59, 0x20000
  s_mov_b32 s60, s24
  s_mov_b32 s61, s25
  s_mov_b32 s62, 163840
  s_mov_b32 s63, 0x20000
  s_mov_b32 s64, s26
  s_mov_b32 s65, s27
  s_mov_b32 s66, 163840
  s_mov_b32 s67, 0x20000
  s_mov_b32 s68, s28
  s_mov_b32 s69, s29
  s_mov_b32 s70, 163840
  s_mov_b32 s71, 0x20000
  s_mov_b32 s72, s30
  s_mov_b32 s73, s31
  s_mov_b32 s74, 1280
  s_mov_b32 s75, 0x20000
  s_mov_b32 s80, s32
  s_mov_b32 s81, s33
  s_mov_b32 s82, 1280
  s_mov_b32 s83, 0x20000
  v_and_b32 v2, 63, v0
  v_lshrrev_b32 v3, 6, v0
  s_nop 0
  v_readfirstlane_b32 s4, v3
  s_lshl_b32 s5, s3, 1
  s_lshr_b32 s6, s4, 1
  s_add_u32 s5, s5, s6
  s_and_b32 s15, s4, 1
  s_lshl_b32 s7, s5, 8
  s_lshl_b32 s6, s15, 7
  s_add_u32 s7, s7, s6
  s_lshl_b32 s8, s5, 1
  v_lshlrev_b32 v4, 1, v2
  v_mov_b32 v5, 0
  buffer_load_ushort v6, v5, s[72:75], s8 offen
  buffer_load_ushort v8, v4, s[48:51], s7 offen nt
  buffer_load_ushort v9, v4, s[52:55], s7 offen nt
  buffer_load_ushort v10, v4, s[56:59], s7 offen nt
  buffer_load_ushort v11, v4, s[60:63], s7 offen nt
  buffer_load_ushort v12, v4, s[64:67], s7 offen nt
  buffer_load_ushort v13, v4, s[68:71], s7 offen nt
  v_cmp_eq_u32 vcc, 0, v2
  v_mov_b32 v120, 0x7f000000
  s_nop 0
  v_cndmask_b32 v120, v120, v5, vcc
  buffer_load_ushort v121, v120, s[80:83], s8 offen
  v_mov_b32 v176, 0
  v_mov_b32 v177, 0
  v_mov_b32 v178, 0
  v_mov_b32 v179, 0
  v_mov_b32 v180, 0
  v_mov_b32 v181, 0
  v_mov_b32 v182, 0
  v_mov_b32 v183, 0
  v_mov_b32 v184, 0
  v_mov_b32 v185, 0
  v_mov_b32 v186, 0
  v_mov_b32 v187, 0
  v_mov_b32 v188, 0
  v_mov_b32 v189, 0
  v_mov_b32 v190, 0
  v_mov_b32 v191, 0
  v_mov_b32 v192, 0
  v_mov_b32 v193, 0
  v_mov_b32 v194, 0
  v_mov_b32 v195, 0
  v_mov_b32 v196, 0
  v_mov_b32 v197, 0
  v_mov_b32 v198, 0
  v_mov_b32 v199, 0
  v_mov_b32 v200, 0
  v_mov_b32 v201, 0
  v_mov_b32 v202, 0
  v_mov_b32 v203, 0
  v_mov_b32 v204, 0
  v_mov_b32 v205, 0
  v_mov_b32 v206, 0
  v_mov_b32 v207, 0
  v_mov_b32 v208, 0
  v_mov_b32 v209, 0
  v_mov_b32 v210, 0
  v_mov_b32 v211, 0
  v_mov_b32 v212, 0
  v_mov_b32 v213, 0
  v_mov_b32 v214, 0
  v_mov_b32 v215, 0
  v_mov_b32 v216, 0
  v_mov_b32 v217, 0
  v_mov_b32 v218, 0
  v_mov_b32 v219, 0
  v_mov_b32 v220, 0
  v_mov_b32 v221, 0
  v_mov_b32 v222, 0
  v_mov_b32 v223, 0
  v_mov_b32 v224, 0
  v_mov_b32 v225, 0
  v_mov_b32 v226, 0
  v_mov_b32 v227, 0
  v_mov_b32 v228, 0
  v_mov_b32 v229, 0
  v_mov_b32 v230, 0
  v_mov_b32 v231, 0
  v_mov_b32 v232, 0
  v_mov_b32 v233, 0
  v_mov_b32 v234, 0
  v_mov_b32 v235, 0
  v_mov_b32 v236, 0
  v_mov_b32 v237, 0
  v_mov_b32 v238, 0
  v_mov_b32 v239, 0
  s_add_u32 s76, s46, 2621440
  s_addc_u32 s77, s47, 0
  s_mov_b32 s78, 2621440
  s_mov_b32 s79, 0x20000
  s_mul_i32 s6, s4, 10240
  v_lshlrev_b32 v20, 2, v2
  v_add_u32 v20, s6, v20
  v_and_b32 v21, 15, v2
  v_mul_u32_u24 v21, 272, v21
  v_lshrrev_b32 v22, 4, v2
  v_lshlrev_b32 v23, 4, v22
  v_add3_u32 v21, v21, v23, s6
  s_mov_b32 s10, 1069066811
  s_mov_b32 s11, 1042479491
  v_and_b32 v23, 15, v2
  s_add_u32 s14, s6, 8704
  v_lshrrev_b32 v122, 1, v22
  v_lshlrev_b32 v122, 8, v122
  v_and_b32 v123, 1, v22
  v_lshl_add_u32 v122, v123, 3, v122
  v_lshl_add_u32 v122, v23, 4, v122
  v_add_u32 v122, s14, v122
  v_cmp_gt_u32 vcc, 2, v22
  v_lshlrev_b32 v123, 3, v23
  v_lshlrev_b32 v124, 2, v23
  v_cndmask_b32 v123, v124, v123, vcc
  v_lshl_add_u32 v123, v22, 7, v123
  v_add_u32 v123, s14, v123
  v_mov_b32 v124, 64
  v_cndmask_b32 v124, v124, 4, vcc
  v_add_u32 v124, v124, v123
  v_lshlrev_b32 v125, 7, v22
  v_lshl_add_u32 v125, v23, 1, v125
  v_add_u32 v125, s14, v125
  s_waitcnt vmcnt(7)
  v_lshlrev_b32 v6, 16, v6
  v_mul_f32 v7, s10, v6
  v_fma_f32 v5, v6, s10, -v7
  v_mov_b32 v36, 849703007
  v_fmac_f32 v5, v6, v36
  v_exp_f32 v7, v7
  v_mul_f32 v5, 1060205080, v5
  v_fmac_f32 v7, v7, v5
  v_cvt_pk_bf16_f32 v7, v7, v7
  v_lshlrev_b32 v7, 16, v7
  s_waitcnt vmcnt(0)
  s_and_b32 s58, s3, 7
  s_lshr_b32 s59, s3, 3
  s_lshl_b32 s59, s59, 2
  s_add_u32 s59, s59, s4
  s_min_u32 s59, s59, 109
  s_mov_b32 s57, s15
  s_mov_b32 s56, s14
  s_lshl_b32 s14, s59, 6
  v_add_u32 v160, s14, v2
  v_mul_u32_u24 v161, 13108, v160
  v_lshrrev_b32 v161, 16, v161
  v_mul_u32_u24 v162, 5, v161
  v_sub_u32 v162, v160, v162
  v_mul_u32_u24 v161, 1280, v161
  v_lshl_add_u32 v161, v162, 7, v161
  s_and_b32 s14, s58, 3
  s_mul_i32 s14, s14, 655360
  s_add_u32 s14, s14, 0
  v_add_u32 v161, s14, v161
  v_subrev_u32 v160, 2560, v160
  v_mul_u32_u24 v162, 9363, v160
  v_lshrrev_b32 v162, 17, v162
  v_mul_u32_u24 v163, 14, v162
  v_sub_u32 v163, v160, v163
  v_mul_u32_u24 v162, 3456, v162
  v_lshl_add_u32 v162, v163, 7, v162
  s_lshr_b32 s14, s58, 2
  s_mul_i32 s14, s14, 1792
  s_add_u32 s14, s14, 0
  v_add_u32 v162, s14, v162
  v_min_u32 v162, 2211836, v162
  s_cmp_lt_u32 s59, 40
  s_cselect_b64 vcc, -1, 0
  s_cselect_b32 s12, s16, s36
  s_cselect_b32 s13, s17, s37
  v_cndmask_b32 v164, v162, v161, vcc
  global_load_dword v166, v164, s[12:13]
  s_lshl_b32 s14, s59, 6
  v_add_u32 v160, s14, v2
  v_mul_u32_u24 v161, 13108, v160
  v_lshrrev_b32 v161, 16, v161
  v_mul_u32_u24 v162, 5, v161
  v_sub_u32 v162, v160, v162
  v_mul_u32_u24 v161, 1280, v161
  v_lshl_add_u32 v161, v162, 7, v161
  s_and_b32 s14, s58, 3
  s_mul_i32 s14, s14, 655360
  s_add_u32 s14, s14, 640
  v_add_u32 v161, s14, v161
  v_subrev_u32 v160, 2560, v160
  v_mul_u32_u24 v162, 9363, v160
  v_lshrrev_b32 v162, 17, v162
  v_mul_u32_u24 v163, 14, v162
  v_sub_u32 v163, v160, v163
  v_mul_u32_u24 v162, 3456, v162
  v_lshl_add_u32 v162, v163, 7, v162
  s_lshr_b32 s14, s58, 2
  s_mul_i32 s14, s14, 1792
  s_add_u32 s14, s14, 1105920
  v_add_u32 v162, s14, v162
  v_min_u32 v162, 2211836, v162
  s_cmp_lt_u32 s59, 40
  s_cselect_b64 vcc, -1, 0
  s_cselect_b32 s12, s16, s36
  s_cselect_b32 s13, s17, s37
  v_cndmask_b32 v164, v162, v161, vcc
  global_load_dword v166, v164, s[12:13]
  s_mov_b32 s15, s57
  s_mov_b32 s14, s56
  v_lshlrev_b32 v8, 16, v8
  v_lshlrev_b32 v9, 16, v9
  v_lshlrev_b32 v10, 16, v10
  v_lshlrev_b32 v11, 16, v11
  v_lshlrev_b32 v12, 16, v12
  v_lshlrev_b32 v13, 16, v13
  v_mul_f32 v36, v7, v8
  v_mul_f32 v37, v7, v9
  v_mul_f32 v10, v7, v10
  v_mul_f32 v11, v7, v11
  v_mul_f32 v36, s10, v36
  v_mul_f32 v37, s11, v37
  v_mul_f32 v128, 0x41000000, v36
  v_exp_f32 v130, v36
  v_mul_f32 v132, 0x43000000, v36
  v_mul_f32 v129, 0x41000000, v37
  v_fract_f32 v131, v37
  v_mul_f32 v133, 0x43000000, v37
  v_exp_f32 v128, v128
  v_cos_f32 v46, v131
  v_exp_f32 v132, v132
  v_fract_f32 v129, v129
  v_sin_f32 v47, v131
  v_fract_f32 v133, v133
  v_cos_f32 v44, v129
  v_mul_f32 v46, v130, v46
  v_cos_f32 v60, v133
  v_sin_f32 v45, v129
  v_mul_f32 v47, v130, v47
  v_sin_f32 v61, v133
  v_mul_f32 v44, v128, v44
  v_mul_f32 v134, 0x44800000, v36
  v_mul_f32 v60, v132, v60
  v_mul_f32 v45, -v128, v45
  v_mul_f32 v135, 0x44800000, v37
  v_mul_f32 v61, v132, v61
  v_pk_mul_f32 v[40:41], v[12:13], v[10:11] op_sel:[1,1] op_sel_hi:[1,0] neg_lo:[1,0]
  v_exp_f32 v134, v134
  v_pk_fma_f32 v[38:39], v[12:13], v[10:11], v[40:41] op_sel:[0,0,0] op_sel_hi:[0,1,1]
  v_fract_f32 v135, v135
  v_xor_b32 v39, 0x80000000, v39
  v_cos_f32 v74, v135
  v_sin_f32 v75, v135
  v_mul_f32 v74, v134, v74
  v_mul_f32 v75, v134, v75
  v_cvt_pk_bf16_f32 v100, v38, v39
  v_mov_b32 v103, 0x3f80
  v_pk_mul_f32 v[14:15], v[60:61], v[60:61] op_sel:[1,1] op_sel_hi:[1,0] neg_lo:[1,0]
  ds_write_b32 v20, v100 offset:0
  ds_write_b32 v20, v103 offset:4352
  v_pk_fma_f32 v[62:63], v[60:61], v[60:61], v[14:15] op_sel:[0,0,0] op_sel_hi:[0,1,1]
  v_pk_mul_f32 v[40:41], v[38:39], v[44:45] op_sel:[1,1] op_sel_hi:[1,0] neg_lo:[1,0]
  v_cvt_pk_bf16_f32 v102, v46, v47
  v_pk_mul_f32 v[14:15], v[62:63], v[60:61] op_sel:[1,1] op_sel_hi:[1,0] neg_lo:[1,0]
  v_pk_fma_f32 v[92:93], v[38:39], v[44:45], v[40:41] op_sel:[0,0,0] op_sel_hi:[0,1,1]
  ds_write_b32 v20, v102 offset:4624
  v_pk_fma_f32 v[64:65], v[62:63], v[60:61], v[14:15] op_sel:[0,0,0] op_sel_hi:[0,1,1]
  v_cvt_pk_bf16_f32 v101, v92, v93
  v_pk_mul_f32 v[42:43], v[46:47], v[46:47] op_sel:[1,1] op_sel_hi:[1,0] neg_lo:[1,0]
  v_pk_mul_f32 v[14:15], v[64:65], v[60:61] op_sel:[1,1] op_sel_hi:[1,0] neg_lo:[1,0]
  ds_write_b32 v20, v101 offset:272
  v_pk_fma_f32 v[48:49], v[46:47], v[46:47], v[42:43] op_sel:[0,0,0] op_sel_hi:[0,1,1]
  v_pk_fma_f32 v[66:67], v[64:65], v[60:61], v[14:15] op_sel:[0,0,0] op_sel_hi:[0,1,1]
  v_pk_mul_f32 v[40:41], v[92:93], v[44:45] op_sel:[1,1] op_sel_hi:[1,0] neg_lo:[1,0]
  v_cvt_pk_bf16_f32 v103, v48, v49
  v_pk_mul_f32 v[14:15], v[66:67], v[60:61] op_sel:[1,1] op_sel_hi:[1,0] neg_lo:[1,0]
  v_pk_fma_f32 v[94:95], v[92:93], v[44:45], v[40:41] op_sel:[0,0,0] op_sel_hi:[0,1,1]
  ds_write_b32 v20, v103 offset:4896
  v_pk_fma_f32 v[68:69], v[66:67], v[60:61], v[14:15] op_sel:[0,0,0] op_sel_hi:[0,1,1]
  v_cvt_pk_bf16_f32 v100, v94, v95
  v_pk_mul_f32 v[42:43], v[48:49], v[46:47] op_sel:[1,1] op_sel_hi:[1,0] neg_lo:[1,0]
  v_pk_mul_f32 v[14:15], v[68:69], v[60:61] op_sel:[1,1] op_sel_hi:[1,0] neg_lo:[1,0]
  ds_write_b32 v20, v100 offset:544
  v_pk_fma_f32 v[50:51], v[48:49], v[46:47], v[42:43] op_sel:[0,0,0] op_sel_hi:[0,1,1]
  v_pk_fma_f32 v[70:71], v[68:69], v[60:61], v[14:15] op_sel:[0,0,0] op_sel_hi:[0,1,1]
  v_pk_mul_f32 v[40:41], v[94:95], v[44:45] op_sel:[1,1] op_sel_hi:[1,0] neg_lo:[1,0]
  v_cvt_pk_bf16_f32 v102, v50, v51
  v_pk_mul_f32 v[14:15], v[70:71], v[60:61] op_sel:[1,1] op_sel_hi:[1,0] neg_lo:[1,0]
  v_pk_fma_f32 v[92:93], v[94:95], v[44:45], v[40:41] op_sel:[0,0,0] op_sel_hi:[0,1,1]
  ds_write_b32 v20, v102 offset:5168
  v_pk_fma_f32 v[72:73], v[70:71], v[60:61], v[14:15] op_sel:[0,0,0] op_sel_hi:[0,1,1]
  v_cvt_pk_bf16_f32 v101, v92, v93
  v_pk_mul_f32 v[42:43], v[50:51], v[46:47] op_sel:[1,1] op_sel_hi:[1,0] neg_lo:[1,0]
  v_pk_mul_f32 v[14:15], v[60:61], v[74:75] op_sel:[1,1] op_sel_hi:[1,0] neg_lo:[1,0]
  ds_write_b32 v20, v101 offset:816
  v_pk_fma_f32 v[52:53], v[50:51], v[46:47], v[42:43] op_sel:[0,0,0] op_sel_hi:[0,1,1]
  v_pk_fma_f32 v[76:77], v[60:61], v[74:75], v[14:15] op_sel:[0,0,0] op_sel_hi:[0,1,1]
  v_pk_mul_f32 v[40:41], v[92:93], v[44:45] op_sel:[1,1] op_sel_hi:[1,0] neg_lo:[1,0]
  v_cvt_pk_bf16_f32 v103, v52, v53
  v_pk_mul_f32 v[14:15], v[62:63], v[74:75] op_sel:[1,1] op_sel_hi:[1,0] neg_lo:[1,0]
  v_pk_fma_f32 v[94:95], v[92:93], v[44:45], v[40:41] op_sel:[0,0,0] op_sel_hi:[0,1,1]
  ds_write_b32 v20, v103 offset:5440
  v_pk_fma_f32 v[78:79], v[62:63], v[74:75], v[14:15] op_sel:[0,0,0] op_sel_hi:[0,1,1]
  v_cvt_pk_bf16_f32 v100, v94, v95
  v_pk_mul_f32 v[42:43], v[52:53], v[46:47] op_sel:[1,1] op_sel_hi:[1,0] neg_lo:[1,0]
  v_pk_mul_f32 v[14:15], v[64:65], v[74:75] op_sel:[1,1] op_sel_hi:[1,0] neg_lo:[1,0]
  ds_write_b32 v20, v100 offset:1088
  v_pk_fma_f32 v[54:55], v[52:53], v[46:47], v[42:43] op_sel:[0,0,0] op_sel_hi:[0,1,1]
  v_pk_fma_f32 v[80:81], v[64:65], v[74:75], v[14:15] op_sel:[0,0,0] op_sel_hi:[0,1,1]
  v_pk_mul_f32 v[40:41], v[94:95], v[44:45] op_sel:[1,1] op_sel_hi:[1,0] neg_lo:[1,0]
  v_cvt_pk_bf16_f32 v102, v54, v55
  v_pk_mul_f32 v[14:15], v[66:67], v[74:75] op_sel:[1,1] op_sel_hi:[1,0] neg_lo:[1,0]
  v_pk_fma_f32 v[92:93], v[94:95], v[44:45], v[40:41] op_sel:[0,0,0] op_sel_hi:[0,1,1]
  ds_write_b32 v20, v102 offset:5712
  v_pk_fma_f32 v[82:83], v[66:67], v[74:75], v[14:15] op_sel:[0,0,0] op_sel_hi:[0,1,1]
  v_cvt_pk_bf16_f32 v101, v92, v93
  v_pk_mul_f32 v[42:43], v[54:55], v[46:47] op_sel:[1,1] op_sel_hi:[1,0] neg_lo:[1,0]
  v_pk_mul_f32 v[14:15], v[68:69], v[74:75] op_sel:[1,1] op_sel_hi:[1,0] neg_lo:[1,0]
  ds_write_b32 v20, v101 offset:1360
  v_pk_fma_f32 v[56:57], v[54:55], v[46:47], v[42:43] op_sel:[0,0,0] op_sel_hi:[0,1,1]
  v_pk_fma_f32 v[84:85], v[68:69], v[74:75], v[14:15] op_sel:[0,0,0] op_sel_hi:[0,1,1]
  v_pk_mul_f32 v[40:41], v[92:93], v[44:45] op_sel:[1,1] op_sel_hi:[1,0] neg_lo:[1,0]
  v_cvt_pk_bf16_f32 v103, v56, v57
  v_pk_mul_f32 v[14:15], v[70:71], v[74:75] op_sel:[1,1] op_sel_hi:[1,0] neg_lo:[1,0]
  v_pk_fma_f32 v[94:95], v[92:93], v[44:45], v[40:41] op_sel:[0,0,0] op_sel_hi:[0,1,1]
  ds_write_b32 v20, v103 offset:5984
  v_pk_fma_f32 v[86:87], v[70:71], v[74:75], v[14:15] op_sel:[0,0,0] op_sel_hi:[0,1,1]
  v_cvt_pk_bf16_f32 v100, v94, v95
  v_pk_mul_f32 v[42:43], v[56:57], v[46:47] op_sel:[1,1] op_sel_hi:[1,0] neg_lo:[1,0]
  v_pk_mul_f32 v[14:15], v[72:73], v[74:75] op_sel:[1,1] op_sel_hi:[1,0] neg_lo:[1,0]
  ds_write_b32 v20, v100 offset:1632
  v_pk_fma_f32 v[58:59], v[56:57], v[46:47], v[42:43] op_sel:[0,0,0] op_sel_hi:[0,1,1]
  v_pk_fma_f32 v[88:89], v[72:73], v[74:75], v[14:15] op_sel:[0,0,0] op_sel_hi:[0,1,1]
  v_pk_mul_f32 v[40:41], v[94:95], v[44:45] op_sel:[1,1] op_sel_hi:[1,0] neg_lo:[1,0]
  v_cvt_pk_bf16_f32 v102, v58, v59
  v_pk_mul_f32 v[14:15], v[74:75], v[74:75] op_sel:[1,1] op_sel_hi:[1,0] neg_lo:[1,0]
  v_pk_fma_f32 v[92:93], v[94:95], v[44:45], v[40:41] op_sel:[0,0,0] op_sel_hi:[0,1,1]
  ds_write_b32 v20, v102 offset:6256
  v_pk_fma_f32 v[90:91], v[74:75], v[74:75], v[14:15] op_sel:[0,0,0] op_sel_hi:[0,1,1]
  v_cvt_pk_bf16_f32 v101, v92, v93
  v_cvt_pk_bf16_f32 v103, v60, v61
  ds_write_b32 v20, v101 offset:1904
  ds_write_b32 v20, v103 offset:6528
  v_pk_mul_f32 v[40:41], v[92:93], v[44:45] op_sel:[1,1] op_sel_hi:[1,0] neg_lo:[1,0]
  v_pk_mul_f32 v[42:43], v[60:61], v[46:47] op_sel:[1,1] op_sel_hi:[1,0] neg_lo:[1,0]
  v_pk_fma_f32 v[94:95], v[92:93], v[44:45], v[40:41] op_sel:[0,0,0] op_sel_hi:[0,1,1]
  v_pk_fma_f32 v[98:99], v[60:61], v[46:47], v[42:43] op_sel:[0,0,0] op_sel_hi:[0,1,1]
  v_cvt_pk_bf16_f32 v100, v94, v95
  v_cvt_pk_bf16_f32 v102, v98, v99
  ds_write_b32 v20, v100 offset:2176
  ds_write_b32 v20, v102 offset:6800
  v_pk_mul_f32 v[40:41], v[94:95], v[44:45] op_sel:[1,1] op_sel_hi:[1,0] neg_lo:[1,0]
  v_pk_mul_f32 v[42:43], v[60:61], v[48:49] op_sel:[1,1] op_sel_hi:[1,0] neg_lo:[1,0]
  v_pk_fma_f32 v[92:93], v[94:95], v[44:45], v[40:41] op_sel:[0,0,0] op_sel_hi:[0,1,1]
  v_pk_fma_f32 v[98:99], v[60:61], v[48:49], v[42:43] op_sel:[0,0,0] op_sel_hi:[0,1,1]
  v_cvt_pk_bf16_f32 v101, v92, v93
  v_cvt_pk_bf16_f32 v103, v98, v99
  ds_write_b32 v20, v101 offset:2448
  ds_write_b32 v20, v103 offset:7072
  v_pk_mul_f32 v[40:41], v[92:93], v[44:45] op_sel:[1,1] op_sel_hi:[1,0] neg_lo:[1,0]
  v_pk_mul_f32 v[42:43], v[60:61], v[50:51] op_sel:[1,1] op_sel_hi:[1,0] neg_lo:[1,0]
  v_pk_fma_f32 v[94:95], v[92:93], v[44:45], v[40:41] op_sel:[0,0,0] op_sel_hi:[0,1,1]
  v_pk_fma_f32 v[98:99], v[60:61], v[50:51], v[42:43] op_sel:[0,0,0] op_sel_hi:[0,1,1]
  v_cvt_pk_bf16_f32 v100, v94, v95
  v_cvt_pk_bf16_f32 v102, v98, v99
  ds_write_b32 v20, v100 offset:2720
  ds_write_b32 v20, v102 offset:7344
  v_pk_mul_f32 v[40:41], v[94:95], v[44:45] op_sel:[1,1] op_sel_hi:[1,0] neg_lo:[1,0]
  v_pk_mul_f32 v[42:43], v[60:61], v[52:53] op_sel:[1,1] op_sel_hi:[1,0] neg_lo:[1,0]
  v_pk_fma_f32 v[92:93], v[94:95], v[44:45], v[40:41] op_sel:[0,0,0] op_sel_hi:[0,1,1]
  v_pk_fma_f32 v[98:99], v[60:61], v[52:53], v[42:43] op_sel:[0,0,0] op_sel_hi:[0,1,1]
  v_cvt_pk_bf16_f32 v101, v92, v93
  v_cvt_pk_bf16_f32 v103, v98, v99
  ds_write_b32 v20, v101 offset:2992
  ds_write_b32 v20, v103 offset:7616
  v_pk_mul_f32 v[40:41], v[92:93], v[44:45] op_sel:[1,1] op_sel_hi:[1,0] neg_lo:[1,0]
  v_pk_mul_f32 v[42:43], v[60:61], v[54:55] op_sel:[1,1] op_sel_hi:[1,0] neg_lo:[1,0]
  v_pk_fma_f32 v[94:95], v[92:93], v[44:45], v[40:41] op_sel:[0,0,0] op_sel_hi:[0,1,1]
  v_pk_fma_f32 v[98:99], v[60:61], v[54:55], v[42:43] op_sel:[0,0,0] op_sel_hi:[0,1,1]
  v_cvt_pk_bf16_f32 v100, v94, v95
  v_cvt_pk_bf16_f32 v102, v98, v99
  ds_write_b32 v20, v100 offset:3264
  ds_write_b32 v20, v102 offset:7888
  v_pk_mul_f32 v[40:41], v[94:95], v[44:45] op_sel:[1,1] op_sel_hi:[1,0] neg_lo:[1,0]
  v_pk_mul_f32 v[42:43], v[60:61], v[56:57] op_sel:[1,1] op_sel_hi:[1,0] neg_lo:[1,0]
  v_pk_fma_f32 v[92:93], v[94:95], v[44:45], v[40:41] op_sel:[0,0,0] op_sel_hi:[0,1,1]
  v_pk_fma_f32 v[98:99], v[60:61], v[56:57], v[42:43] op_sel:[0,0,0] op_sel_hi:[0,1,1]
  v_cvt_pk_bf16_f32 v101, v92, v93
  v_cvt_pk_bf16_f32 v103, v98, v99
  ds_write_b32 v20, v101 offset:3536
  ds_write_b32 v20, v103 offset:8160
  v_pk_mul_f32 v[40:41], v[92:93], v[44:45] op_sel:[1,1] op_sel_hi:[1,0] neg_lo:[1,0]
  v_pk_mul_f32 v[42:43], v[60:61], v[58:59] op_sel:[1,1] op_sel_hi:[1,0] neg_lo:[1,0]
  v_pk_fma_f32 v[94:95], v[92:93], v[44:45], v[40:41] op_sel:[0,0,0] op_sel_hi:[0,1,1]
  v_pk_fma_f32 v[98:99], v[60:61], v[58:59], v[42:43] op_sel:[0,0,0] op_sel_hi:[0,1,1]
  v_cvt_pk_bf16_f32 v100, v94, v95
  v_cvt_pk_bf16_f32 v102, v98, v99
  ds_write_b32 v20, v100 offset:3808
  ds_write_b32 v20, v102 offset:8432
  v_pk_mul_f32 v[40:41], v[94:95], v[44:45] op_sel:[1,1] op_sel_hi:[1,0] neg_lo:[1,0]
  v_pk_fma_f32 v[92:93], v[94:95], v[44:45], v[40:41] op_sel:[0,0,0] op_sel_hi:[0,1,1]
  v_cvt_pk_bf16_f32 v101, v92, v93
  ds_write_b32 v20, v101 offset:4080
  ds_read_b128 v[104:107], v21 offset:0
  ds_read_b128 v[108:111], v21 offset:64
  ds_read_b128 v[112:115], v21 offset:128
  ds_read_b128 v[116:119], v21 offset:192
  ds_read_b128 v[128:131], v21 offset:4352
  ds_read_b128 v[132:135], v21 offset:4416
  ds_read_b128 v[136:139], v21 offset:4480
  ds_read_b128 v[140:143], v21 offset:4544
  v_cvt_pk_bf16_f32 v100, v62, v63
  v_cvt_pk_bf16_f32 v103, v66, v67
  v_cvt_pk_bf16_f32 v18, v74, v75
  ds_write_b32 v20, v100 offset:0
  ds_write_b32 v20, v103 offset:2176
  ds_write_b32 v20, v18 offset:4352
  v_pk_mul_f32 v[40:41], v[62:63], v[48:49] op_sel:[1,1] op_sel_hi:[1,0] neg_lo:[1,0]
  v_pk_mul_f32 v[42:43], v[66:67], v[52:53] op_sel:[1,1] op_sel_hi:[1,0] neg_lo:[1,0]
  v_cvt_pk_bf16_f32 v19, v76, v77
  v_pk_fma_f32 v[96:97], v[62:63], v[48:49], v[40:41] op_sel:[0,0,0] op_sel_hi:[0,1,1]
  v_pk_fma_f32 v[98:99], v[66:67], v[52:53], v[42:43] op_sel:[0,0,0] op_sel_hi:[0,1,1]
  ds_write_b32 v20, v19 offset:4624
  v_cvt_pk_bf16_f32 v101, v96, v97
  v_cvt_pk_bf16_f32 v102, v98, v99
  v_cvt_pk_bf16_f32 v18, v78, v79
  ds_write_b32 v20, v101 offset:272
  ds_write_b32 v20, v102 offset:2448
  ds_write_b32 v20, v18 offset:4896
  v_pk_mul_f32 v[40:41], v[62:63], v[52:53] op_sel:[1,1] op_sel_hi:[1,0] neg_lo:[1,0]
  v_cvt_pk_bf16_f32 v103, v68, v69
  v_cvt_pk_bf16_f32 v19, v80, v81
  v_pk_fma_f32 v[96:97], v[62:63], v[52:53], v[40:41] op_sel:[0,0,0] op_sel_hi:[0,1,1]
  ds_write_b32 v20, v103 offset:2720
  ds_write_b32 v20, v19 offset:5168
  v_cvt_pk_bf16_f32 v100, v96, v97
  v_pk_mul_f32 v[42:43], v[68:69], v[52:53] op_sel:[1,1] op_sel_hi:[1,0] neg_lo:[1,0]
  v_cvt_pk_bf16_f32 v18, v82, v83
  ds_write_b32 v20, v100 offset:544
  v_pk_fma_f32 v[98:99], v[68:69], v[52:53], v[42:43] op_sel:[0,0,0] op_sel_hi:[0,1,1]
  ds_write_b32 v20, v18 offset:5440
  v_pk_mul_f32 v[40:41], v[62:63], v[56:57] op_sel:[1,1] op_sel_hi:[1,0] neg_lo:[1,0]
  v_cvt_pk_bf16_f32 v102, v98, v99
  v_cvt_pk_bf16_f32 v19, v84, v85
  v_pk_fma_f32 v[96:97], v[62:63], v[56:57], v[40:41] op_sel:[0,0,0] op_sel_hi:[0,1,1]
  ds_write_b32 v20, v102 offset:2992
  ds_write_b32 v20, v19 offset:5712
  v_cvt_pk_bf16_f32 v101, v96, v97
  v_cvt_pk_bf16_f32 v103, v70, v71
  v_cvt_pk_bf16_f32 v18, v86, v87
  ds_write_b32 v20, v101 offset:816
  ds_write_b32 v20, v103 offset:3264
  ds_write_b32 v20, v18 offset:5984
  v_cvt_pk_bf16_f32 v100, v64, v65
  v_pk_mul_f32 v[42:43], v[70:71], v[52:53] op_sel:[1,1] op_sel_hi:[1,0] neg_lo:[1,0]
  v_cvt_pk_bf16_f32 v19, v88, v89
  ds_write_b32 v20, v100 offset:1088
  v_pk_fma_f32 v[98:99], v[70:71], v[52:53], v[42:43] op_sel:[0,0,0] op_sel_hi:[0,1,1]
  ds_write_b32 v20, v19 offset:6256
  v_pk_mul_f32 v[40:41], v[64:65], v[48:49] op_sel:[1,1] op_sel_hi:[1,0] neg_lo:[1,0]
  v_cvt_pk_bf16_f32 v102, v98, v99
  v_cvt_pk_bf16_f32 v18, v90, v91
  v_pk_fma_f32 v[96:97], v[64:65], v[48:49], v[40:41] op_sel:[0,0,0] op_sel_hi:[0,1,1]
  ds_write_b32 v20, v102 offset:3536
  ds_write_b32 v20, v18 offset:6528
  v_cvt_pk_bf16_f32 v101, v96, v97
  v_cvt_pk_bf16_f32 v103, v72, v73
  ds_write_b32 v20, v101 offset:1360
  ds_write_b32 v20, v103 offset:3808
  v_pk_mul_f32 v[40:41], v[64:65], v[52:53] op_sel:[1,1] op_sel_hi:[1,0] neg_lo:[1,0]
  v_pk_mul_f32 v[42:43], v[72:73], v[52:53] op_sel:[1,1] op_sel_hi:[1,0] neg_lo:[1,0]
  v_pk_fma_f32 v[96:97], v[64:65], v[52:53], v[40:41] op_sel:[0,0,0] op_sel_hi:[0,1,1]
  v_pk_fma_f32 v[98:99], v[72:73], v[52:53], v[42:43] op_sel:[0,0,0] op_sel_hi:[0,1,1]
  v_cvt_pk_bf16_f32 v100, v96, v97
  v_cvt_pk_bf16_f32 v102, v98, v99
  ds_write_b32 v20, v100 offset:1632
  ds_write_b32 v20, v102 offset:4080
  v_pk_mul_f32 v[40:41], v[64:65], v[56:57] op_sel:[1,1] op_sel_hi:[1,0] neg_lo:[1,0]
  v_pk_fma_f32 v[96:97], v[64:65], v[56:57], v[40:41] op_sel:[0,0,0] op_sel_hi:[0,1,1]
  v_cvt_pk_bf16_f32 v101, v96, v97
  ds_write_b32 v20, v101 offset:1904
  ds_read_b128 v[144:147], v21 offset:0
  ds_read_b128 v[148:151], v21 offset:64
  ds_read_b128 v[152:155], v21 offset:128
  ds_read_b128 v[156:159], v21 offset:192
  s_waitcnt lgkmcnt(15)
  v_mfma_f32_16x16x32_bf16 v[24:27], v[128:131], v[104:107], 0
  v_mfma_f32_16x16x32_bf16 v[24:27], v[132:135], v[108:111], v[24:27]
  v_mfma_f32_16x16x32_bf16 v[24:27], v[136:139], v[112:115], v[24:27]
  v_mfma_f32_16x16x32_bf16 v[24:27], v[140:143], v[116:119], v[24:27]
  ds_read_b128 v[46:49], v21 offset:4352
  ds_read_b128 v[50:53], v21 offset:4416
  ds_read_b128 v[54:57], v21 offset:4480
  ds_read_b128 v[58:61], v21 offset:4544
  s_waitcnt lgkmcnt(4)
  v_mfma_f32_16x16x32_bf16 v[28:31], v[144:147], v[104:107], 0
  v_mfma_f32_16x16x32_bf16 v[28:31], v[148:151], v[108:111], v[28:31]
  v_mfma_f32_16x16x32_bf16 v[28:31], v[152:155], v[112:115], v[28:31]
  v_mfma_f32_16x16x32_bf16 v[28:31], v[156:159], v[116:119], v[28:31]
  s_waitcnt lgkmcnt(0)
  v_mfma_f32_16x16x32_bf16 v[32:35], v[46:49], v[104:107], 0
  v_mfma_f32_16x16x32_bf16 v[32:35], v[50:53], v[108:111], v[32:35]
  v_mfma_f32_16x16x32_bf16 v[32:35], v[54:57], v[112:115], v[32:35]
  v_mfma_f32_16x16x32_bf16 v[32:35], v[58:61], v[116:119], v[32:35]
  v_lshlrev_b32 v46, 4, v2
  v_add_u32 v47, s6, v46
  s_cmp_eq_u32 s15, 0
  s_cbranch_scc1 kgh0_2
  ds_write_b128 v47, v[24:27] offset:0
  ds_write_b128 v47, v[28:31] offset:1024
  s_nop 1
  ds_write_b128 v47, v[32:35] offset:2048
  s_waitcnt lgkmcnt(0)
  s_barrier
  s_branch kgdone_1
kgh0_2:
  s_barrier
  ds_read_b128 v[48:51], v47 offset:10240
  ds_read_b128 v[52:55], v47 offset:11264
  ds_read_b128 v[56:59], v47 offset:12288
  s_waitcnt lgkmcnt(0)
  v_pk_add_f32 v[24:25], v[24:25], v[48:49]
  v_pk_add_f32 v[26:27], v[26:27], v[50:51]
  v_pk_add_f32 v[28:29], v[28:29], v[52:53]
  v_pk_add_f32 v[30:31], v[30:31], v[54:55]
  v_pk_add_f32 v[32:33], v[32:33], v[56:57]
  v_pk_add_f32 v[34:35], v[34:35], v[58:59]
  v_lshlrev_b32 v121, 16, v121
  v_add_f32 v24, v24, v121
  v_cvt_pk_bf16_f32 v40, v24, v25
  v_cvt_pk_bf16_f32 v41, v26, v27
  ds_write_b64 v122, v[40:41]
  v_cvt_pk_bf16_f32 v42, v28, v29
  v_cvt_pk_bf16_f32 v43, v30, v31
  ds_write_b32 v123, v42 offset:512
  ds_write_b32 v124, v43 offset:512
  v_cvt_pk_bf16_f32 v44, v32, v33
  v_cvt_pk_bf16_f32 v45, v34, v35
  ds_write_b16 v125, v44 offset:1024
  ds_write_b16_d16_hi v125, v44 offset:1056
  ds_write_b16 v125, v45 offset:1088
  ds_write_b16_d16_hi v125, v45 offset:1120
  v_cmp_gt_u32 vcc, 32, v2
  v_lshlrev_b32 v46, 4, v2
  v_lshlrev_b32 v47, 3, v2
  v_add_u32 v47, 256, v47
  v_cndmask_b32 v47, v47, v46, vcc
  v_add_u32 v47, s14, v47
  ds_read2_b64 v[48:51], v47 offset0:0 offset1:1
  v_lshlrev_b32 v47, 2, v2
  v_add_u32 v47, s14, v47
  ds_read2_b32 v[52:53], v47 offset0:192 offset1:193
  v_add_u32 v47, s14, v4
  ds_read_u16 v54, v47 offset:1024
  ds_read_u16 v55, v47 offset:1026
  ds_read_u16 v56, v47 offset:1152
  ds_read_u16 v57, v47 offset:1154
  v_mov_b32 v58, 0x01000100
  v_mov_b32 v59, 0x03020100
  v_cndmask_b32 v58, v58, v59, vcc
  v_mov_b32 v59, 0x05040302
  v_mov_b32 v60, 0x07060504
  v_cndmask_b32 v59, v59, v60, vcc
  v_mov_b32 v61, 0x01000100
  v_cndmask_b32 v60, v61, v60, vcc
  s_mov_b32 s9, 0x05040302
  s_mov_b32 s12, 0x01000100
  s_mov_b32 s13, 0x03020302
  v_and_b32 v61, 1, v2
  v_mul_u32_u24 v61, 0x0404, v61
  v_add_u32 v61, 0x05040100, v61
  s_lshl_b32 s7, s5, 12
  s_waitcnt lgkmcnt(5)
  v_perm_b32 v64, v49, v48, v58
  v_perm_b32 v65, v49, v48, v59
  v_perm_b32 v66, v50, v49, v60
  v_perm_b32 v67, v50, v49, s9
  v_cndmask_b32 v67, v67, v51, vcc
  buffer_store_dwordx4 v[64:67], v46, s[76:79], s7 offen sc1
  s_waitcnt lgkmcnt(4)
  v_perm_b32 v68, v52, v52, s12
  v_mov_b32 v69, v52
  v_perm_b32 v70, v52, v52, s13
  v_perm_b32 v71, v53, v53, s12
  buffer_store_dwordx4 v[68:71], v46, s[76:79], s7 offen offset:1024 sc1
  s_waitcnt lgkmcnt(0)
  v_perm_b32 v72, v54, v54, s12
  v_perm_b32 v73, v54, v54, s12
  v_perm_b32 v74, v55, v54, v61
  v_perm_b32 v75, v55, v55, s12
  buffer_store_dwordx4 v[72:75], v46, s[76:79], s7 offen offset:2048 sc1
  v_perm_b32 v76, v56, v56, s12
  v_perm_b32 v77, v56, v56, s12
  v_perm_b32 v78, v57, v56, v61
  v_perm_b32 v79, v57, v57, s12
  buffer_store_dwordx4 v[76:79], v46, s[76:79], s7 offen offset:3072 sc1
kgdone_1:
  s_mov_b32 s48, s16
  s_mov_b32 s49, s17
  s_mov_b32 s50, 2621440
  s_mov_b32 s51, 0x20000
  s_mov_b32 s52, s36
  s_mov_b32 s53, s37
  s_mov_b32 s54, 2211840
  s_mov_b32 s55, 0x20000
  s_and_b32 s4, s3, 7
  s_lshr_b32 s5, s3, 3
  s_and_b32 s6, s4, 3
  s_lshl_b32 s6, s6, 2
  s_and_b32 s7, s5, 3
  s_add_u32 s6, s6, s7
  s_lshr_b32 s7, s4, 2
  s_mul_i32 s7, s7, 7
  s_lshr_b32 s8, s5, 2
  s_add_u32 s7, s7, s8
  v_readfirstlane_b32 s8, v3
  s_lshl_b32 s11, s6, 7
  s_lshl_b32 s12, s8, 5
  s_add_u32 s11, s11, s12
  s_mul_i32 s11, s11, 1280
  v_lshrrev_b32 v4, 2, v2
  v_mul_u32_u24 v4, 1280, v4
  v_bfe_u32 v5, v2, 4, 2
  v_and_b32 v6, 3, v2
  v_xor_b32 v6, v6, v5
  v_lshl_add_u32 v4, v6, 4, v4
  v_mul_u32_u24 v7, 3456, v5
  v_and_b32 v6, 15, v2
  v_lshlrev_b32 v8, 2, v5
  v_xor_b32 v6, v6, v8
  v_lshl_add_u32 v5, v6, 4, v7
  s_mul_i32 s12, s8, 27648
  s_lshl_b32 s13, s7, 8
  s_add_u32 s12, s12, s13
  s_lshl_b32 s13, s8, 11
  s_waitcnt lgkmcnt(0)
  s_barrier
  s_add_u32 m0, s13, 0
  s_add_u32 s14, s11, 20480
  buffer_load_dwordx4 v4, s[48:51], s11 offen lds
  s_add_u32 m0, s13, 1024
  s_add_u32 s11, s11, 64
  buffer_load_dwordx4 v4, s[48:51], s14 offen lds
  s_add_u32 m0, s13, 8192
  s_add_u32 s14, s12, 13824
  buffer_load_dwordx4 v5, s[52:55], s12 offen lds
  s_add_u32 m0, s13, 9216
  s_add_u32 s12, s12, 110592
  buffer_load_dwordx4 v5, s[52:55], s14 offen lds
  s_add_u32 m0, s13, 16384
  s_add_u32 s14, s11, 20480
  buffer_load_dwordx4 v4, s[48:51], s11 offen lds
  s_add_u32 m0, s13, 17408
  s_add_u32 s11, s11, 64
  buffer_load_dwordx4 v4, s[48:51], s14 offen lds
  s_add_u32 m0, s13, 24576
  s_add_u32 s14, s12, 13824
  buffer_load_dwordx4 v5, s[52:55], s12 offen lds
  s_add_u32 m0, s13, 25600
  s_add_u32 s12, s12, 110592
  buffer_load_dwordx4 v5, s[52:55], s14 offen lds
  s_add_u32 m0, s13, 32768
  s_add_u32 s14, s11, 20480
  buffer_load_dwordx4 v4, s[48:51], s11 offen lds
  s_add_u32 m0, s13, 33792
  s_add_u32 s11, s11, 64
  buffer_load_dwordx4 v4, s[48:51], s14 offen lds
  s_add_u32 m0, s13, 40960
  s_add_u32 s14, s12, 13824
  buffer_load_dwordx4 v5, s[52:55], s12 offen lds
  s_add_u32 m0, s13, 41984
  s_add_u32 s12, s12, 110592
  buffer_load_dwordx4 v5, s[52:55], s14 offen lds
  s_add_u32 s56, s46, 8388608
  s_addc_u32 s57, s47, 0
  s_mov_b32 s58, 7077888
  s_mov_b32 s59, 0x20000
  s_mov_b32 s60, s38
  s_mov_b32 s61, s39
  s_mov_b32 s62, 3456
  s_mov_b32 s63, 0x20000
  s_mov_b32 s76, s44
  s_mov_b32 s77, s45
  s_mov_b32 s78, 256
  s_mov_b32 s79, 0x20000
  s_add_u32 s80, s46, 20971520
  s_addc_u32 s81, s47, 0
  s_mov_b32 s82, 79872
  s_mov_b32 s83, 0x20000
  s_and_b32 s9, s8, 1
  s_lshr_b32 s10, s8, 1
  s_lshl_b32 s14, s9, 1
  s_add_u32 s67, s14, s10
  s_xor_b32 s68, s67, 1
  v_and_b32 v6, 31, v2
  v_lshrrev_b32 v7, 5, v2
  v_bfe_u32 v8, v2, 2, 2
  v_xor_b32 v8, v8, v7
  v_lshlrev_b32 v9, 6, v6
  v_lshl_add_u32 v9, v8, 4, v9
  s_lshl_b32 s14, s10, 1
  s_add_u32 s15, s14, s9
  s_xor_b32 s64, s15, 1
  s_lshl_b32 s65, s15, 11
  s_lshl_b32 s66, s64, 11
  v_add_u32 v10, s65, v9
  v_xor_b32 v11, 32, v10
  v_add_u32 v12, s66, v9
  v_xor_b32 v13, 32, v12
  v_bfe_u32 v14, v2, 4, 1
  v_bfe_u32 v15, v2, 2, 2
  v_and_b32 v16, 3, v2
  v_lshlrev_b32 v17, 3, v7
  v_add_u32 v17, v17, v15
  v_lshlrev_b32 v17, 8, v17
  v_lshl_add_u32 v17, v14, 5, v17
  v_lshl_add_u32 v17, v16, 3, v17
  v_add_u32 v17, 8192, v17
  v_xor_b32 v18, s67, v15
  v_lshl_add_u32 v14, v18, 6, v17
  v_xor_b32 v18, s68, v15
  v_lshl_add_u32 v15, v18, 6, v17
  s_lshl_b32 s14, s7, 7
  s_lshl_b32 s69, s67, 5
  s_add_u32 s69, s69, s14
  s_lshl_b32 s70, s68, 5
  s_add_u32 s70, s70, s14
  v_add_u32 v16, s69, v6
  v_lshlrev_b32 v16, 1, v16
  v_add_u32 v17, s70, v6
  v_lshlrev_b32 v17, 1, v17
  v_lshlrev_b32 v22, 2, v16
  v_add_u32 v22, 0x10000, v22
  v_lshlrev_b32 v23, 2, v17
  v_add_u32 v23, 0x10000, v23
  s_lshl_b32 s14, s6, 7
  s_lshl_b32 s69, s15, 5
  s_add_u32 s69, s69, s14
  s_lshl_b32 s70, s64, 5
  s_add_u32 s70, s70, s14
  v_add_u32 v24, s69, v6
  v_lshlrev_b32 v24, 3, v24
  v_add_u32 v25, s70, v6
  v_lshlrev_b32 v25, 3, v25
  v_mov_b32 v26, 0
  s_cmp_eq_u32 s7, 13
  s_cselect_b32 s14, s9, 0
  s_cmp_lg_u32 s14, 0
  s_cselect_b64 vcc, -1, 0
  v_cndmask_b32 v22, v22, v24, vcc
  v_cndmask_b32 v23, v23, v24, vcc
  v_mov_b32 v164, 0x3f803f80
  v_mov_b32 v165, 0x3f803f80
  v_mov_b32 v48, 0
  v_mov_b32 v49, 0
  v_mov_b32 v50, 0
  v_mov_b32 v51, 0
  v_mov_b32 v52, 0
  v_mov_b32 v53, 0
  v_mov_b32 v54, 0
  v_mov_b32 v55, 0
  v_mov_b32 v56, 0
  v_mov_b32 v57, 0
  v_mov_b32 v58, 0
  v_mov_b32 v59, 0
  v_mov_b32 v60, 0
  v_mov_b32 v61, 0
  v_mov_b32 v62, 0
  v_mov_b32 v63, 0
  s_mov_b32 s72, 0
g1loop_3:
  s_waitcnt vmcnt(8) lgkmcnt(0)
  s_barrier
  v_mfma_f32_32x32x16_bf16 v[176:191], v[48:51], v[56:59], v[176:191]
  ds_read_b64_tr_b16 v[32:33], v14 offset:0
  ds_read_b64_tr_b16 v[34:35], v14 offset:1024
  ds_read_b128 v[40:43], v10 offset:0
  v_mfma_f32_32x32x16_bf16 v[192:207], v[48:51], v[60:63], v[192:207]
  ds_read_b128 v[44:47], v12 offset:0
  ds_read_b64_tr_b16 v[36:37], v15 offset:0
  ds_read_b64_tr_b16 v[38:39], v15 offset:1024
  v_mfma_f32_32x32x16_bf16 v[208:223], v[52:55], v[56:59], v[208:223]
  s_add_u32 m0, s13, 49152
  s_add_u32 s14, s11, 20480
  buffer_load_dwordx4 v4, s[48:51], s11 offen lds
  v_mfma_f32_32x32x16_bf16 v[224:239], v[52:55], v[60:63], v[224:239]
  s_add_u32 m0, s13, 50176
  s_add_u32 s11, s11, 64
  buffer_load_dwordx4 v4, s[48:51], s14 offen lds
  s_waitcnt lgkmcnt(0)
  v_mfma_f32_32x32x16_bf16 v[176:191], v[32:35], v[40:43], v[176:191]
  ds_read_b64_tr_b16 v[48:49], v14 offset:4096
  ds_read_b64_tr_b16 v[50:51], v14 offset:5120
  ds_read_b128 v[56:59], v11 offset:0
  v_mfma_f32_32x32x16_bf16 v[192:207], v[32:35], v[44:47], v[192:207]
  ds_read_b128 v[60:63], v13 offset:0
  ds_read_b64_tr_b16 v[52:53], v15 offset:4096
  ds_read_b64_tr_b16 v[54:55], v15 offset:5120
  v_mfma_f32_32x32x16_bf16 v[208:223], v[36:39], v[40:43], v[208:223]
  s_add_u32 m0, s13, 57344
  s_add_u32 s14, s12, 13824
  buffer_load_dwordx4 v5, s[52:55], s12 offen lds
  v_mfma_f32_32x32x16_bf16 v[224:239], v[36:39], v[44:47], v[224:239]
  s_add_u32 m0, s13, 58368
  s_add_u32 s12, s12, 110592
  buffer_load_dwordx4 v5, s[52:55], s14 offen lds
  s_waitcnt vmcnt(8) lgkmcnt(0)
  s_barrier
  v_mfma_f32_32x32x16_bf16 v[176:191], v[48:51], v[56:59], v[176:191]
  ds_read_b64_tr_b16 v[32:33], v14 offset:16384
  ds_read_b64_tr_b16 v[34:35], v14 offset:17408
  ds_read_b128 v[40:43], v10 offset:16384
  v_mfma_f32_32x32x16_bf16 v[192:207], v[48:51], v[60:63], v[192:207]
  ds_read_b128 v[44:47], v12 offset:16384
  ds_read_b64_tr_b16 v[36:37], v15 offset:16384
  ds_read_b64_tr_b16 v[38:39], v15 offset:17408
  v_mfma_f32_32x32x16_bf16 v[208:223], v[52:55], v[56:59], v[208:223]
  s_add_u32 m0, s13, 0
  s_add_u32 s14, s11, 20480
  buffer_load_dwordx4 v4, s[48:51], s11 offen lds
  v_mfma_f32_32x32x16_bf16 v[224:239], v[52:55], v[60:63], v[224:239]
  s_add_u32 m0, s13, 1024
  s_add_u32 s11, s11, 64
  buffer_load_dwordx4 v4, s[48:51], s14 offen lds
  s_waitcnt lgkmcnt(0)
  v_mfma_f32_32x32x16_bf16 v[176:191], v[32:35], v[40:43], v[176:191]
  ds_read_b64_tr_b16 v[48:49], v14 offset:20480
  ds_read_b64_tr_b16 v[50:51], v14 offset:21504
  ds_read_b128 v[56:59], v11 offset:16384
  v_mfma_f32_32x32x16_bf16 v[192:207], v[32:35], v[44:47], v[192:207]
  ds_read_b128 v[60:63], v13 offset:16384
  ds_read_b64_tr_b16 v[52:53], v15 offset:20480
  ds_read_b64_tr_b16 v[54:55], v15 offset:21504
  v_mfma_f32_32x32x16_bf16 v[208:223], v[36:39], v[40:43], v[208:223]
  s_add_u32 m0, s13, 8192
  s_add_u32 s14, s12, 13824
  buffer_load_dwordx4 v5, s[52:55], s12 offen lds
  v_mfma_f32_32x32x16_bf16 v[224:239], v[36:39], v[44:47], v[224:239]
  s_add_u32 m0, s13, 9216
  s_add_u32 s12, s12, 110592
  buffer_load_dwordx4 v5, s[52:55], s14 offen lds
  s_waitcnt vmcnt(8) lgkmcnt(0)
  s_barrier
  v_mfma_f32_32x32x16_bf16 v[176:191], v[48:51], v[56:59], v[176:191]
  ds_read_b64_tr_b16 v[32:33], v14 offset:32768
  ds_read_b64_tr_b16 v[34:35], v14 offset:33792
  ds_read_b128 v[40:43], v10 offset:32768
  v_mfma_f32_32x32x16_bf16 v[192:207], v[48:51], v[60:63], v[192:207]
  ds_read_b128 v[44:47], v12 offset:32768
  ds_read_b64_tr_b16 v[36:37], v15 offset:32768
  ds_read_b64_tr_b16 v[38:39], v15 offset:33792
  v_mfma_f32_32x32x16_bf16 v[208:223], v[52:55], v[56:59], v[208:223]
  s_add_u32 m0, s13, 16384
  s_add_u32 s14, s11, 20480
  buffer_load_dwordx4 v4, s[48:51], s11 offen lds
  v_mfma_f32_32x32x16_bf16 v[224:239], v[52:55], v[60:63], v[224:239]
  s_add_u32 m0, s13, 17408
  s_add_u32 s11, s11, 64
  buffer_load_dwordx4 v4, s[48:51], s14 offen lds
  s_waitcnt lgkmcnt(0)
  v_mfma_f32_32x32x16_bf16 v[176:191], v[32:35], v[40:43], v[176:191]
  ds_read_b64_tr_b16 v[48:49], v14 offset:36864
  ds_read_b64_tr_b16 v[50:51], v14 offset:37888
  ds_read_b128 v[56:59], v11 offset:32768
  v_mfma_f32_32x32x16_bf16 v[192:207], v[32:35], v[44:47], v[192:207]
  ds_read_b128 v[60:63], v13 offset:32768
  ds_read_b64_tr_b16 v[52:53], v15 offset:36864
  ds_read_b64_tr_b16 v[54:55], v15 offset:37888
  v_mfma_f32_32x32x16_bf16 v[208:223], v[36:39], v[40:43], v[208:223]
  s_add_u32 m0, s13, 24576
  s_add_u32 s14, s12, 13824
  buffer_load_dwordx4 v5, s[52:55], s12 offen lds
  v_mfma_f32_32x32x16_bf16 v[224:239], v[36:39], v[44:47], v[224:239]
  s_add_u32 m0, s13, 25600
  s_add_u32 s12, s12, 110592
  buffer_load_dwordx4 v5, s[52:55], s14 offen lds
  s_waitcnt vmcnt(8) lgkmcnt(0)
  s_barrier
  v_mfma_f32_32x32x16_bf16 v[176:191], v[48:51], v[56:59], v[176:191]
  ds_read_b64_tr_b16 v[32:33], v14 offset:49152
  ds_read_b64_tr_b16 v[34:35], v14 offset:50176
  ds_read_b128 v[40:43], v10 offset:49152
  v_mfma_f32_32x32x16_bf16 v[192:207], v[48:51], v[60:63], v[192:207]
  ds_read_b128 v[44:47], v12 offset:49152
  ds_read_b64_tr_b16 v[36:37], v15 offset:49152
  ds_read_b64_tr_b16 v[38:39], v15 offset:50176
  v_mfma_f32_32x32x16_bf16 v[208:223], v[52:55], v[56:59], v[208:223]
  s_add_u32 m0, s13, 32768
  s_add_u32 s14, s11, 20480
  buffer_load_dwordx4 v4, s[48:51], s11 offen lds
  v_mfma_f32_32x32x16_bf16 v[224:239], v[52:55], v[60:63], v[224:239]
  s_add_u32 m0, s13, 33792
  s_add_u32 s11, s11, 64
  buffer_load_dwordx4 v4, s[48:51], s14 offen lds
  s_waitcnt lgkmcnt(0)
  v_mfma_f32_32x32x16_bf16 v[176:191], v[32:35], v[40:43], v[176:191]
  ds_read_b64_tr_b16 v[48:49], v14 offset:53248
  ds_read_b64_tr_b16 v[50:51], v14 offset:54272
  ds_read_b128 v[56:59], v11 offset:49152
  v_mfma_f32_32x32x16_bf16 v[192:207], v[32:35], v[44:47], v[192:207]
  ds_read_b128 v[60:63], v13 offset:49152
  ds_read_b64_tr_b16 v[52:53], v15 offset:53248
  ds_read_b64_tr_b16 v[54:55], v15 offset:54272
  v_mfma_f32_32x32x16_bf16 v[208:223], v[36:39], v[40:43], v[208:223]
  s_add_u32 m0, s13, 40960
  s_add_u32 s14, s12, 13824
  buffer_load_dwordx4 v5, s[52:55], s12 offen lds
  v_mfma_f32_32x32x16_bf16 v[224:239], v[36:39], v[44:47], v[224:239]
  s_add_u32 m0, s13, 41984
  s_add_u32 s12, s12, 110592
  buffer_load_dwordx4 v5, s[52:55], s14 offen lds
  s_add_u32 s72, s72, 1
  s_cmp_lt_u32 s72, 4
  s_cbranch_scc1 g1loop_3
  s_waitcnt vmcnt(8) lgkmcnt(0)
  s_barrier
  v_mfma_f32_32x32x16_bf16 v[176:191], v[48:51], v[56:59], v[176:191]
  ds_read_b64_tr_b16 v[32:33], v14 offset:0
  ds_read_b64_tr_b16 v[34:35], v14 offset:1024
  ds_read_b128 v[40:43], v10 offset:0
  v_mfma_f32_32x32x16_bf16 v[192:207], v[48:51], v[60:63], v[192:207]
  ds_read_b128 v[44:47], v12 offset:0
  ds_read_b64_tr_b16 v[36:37], v15 offset:0
  ds_read_b64_tr_b16 v[38:39], v15 offset:1024
  v_mfma_f32_32x32x16_bf16 v[208:223], v[52:55], v[56:59], v[208:223]
  s_add_u32 m0, s13, 49152
  s_add_u32 s14, s11, 20480
  buffer_load_dwordx4 v4, s[48:51], s11 offen lds
  v_mfma_f32_32x32x16_bf16 v[224:239], v[52:55], v[60:63], v[224:239]
  s_add_u32 m0, s13, 50176
  s_add_u32 s11, s11, 64
  buffer_load_dwordx4 v4, s[48:51], s14 offen lds
  s_waitcnt lgkmcnt(0)
  v_mfma_f32_32x32x16_bf16 v[176:191], v[32:35], v[40:43], v[176:191]
  ds_read_b64_tr_b16 v[48:49], v14 offset:4096
  ds_read_b64_tr_b16 v[50:51], v14 offset:5120
  ds_read_b128 v[56:59], v11 offset:0
  v_mfma_f32_32x32x16_bf16 v[192:207], v[32:35], v[44:47], v[192:207]
  ds_read_b128 v[60:63], v13 offset:0
  ds_read_b64_tr_b16 v[52:53], v15 offset:4096
  ds_read_b64_tr_b16 v[54:55], v15 offset:5120
  v_mfma_f32_32x32x16_bf16 v[208:223], v[36:39], v[40:43], v[208:223]
  s_add_u32 m0, s13, 57344
  s_add_u32 s14, s12, 13824
  buffer_load_dwordx4 v5, s[52:55], s12 offen lds
  v_mfma_f32_32x32x16_bf16 v[224:239], v[36:39], v[44:47], v[224:239]
  s_add_u32 m0, s13, 58368
  s_add_u32 s12, s12, 110592
  buffer_load_dwordx4 v5, s[52:55], s14 offen lds
  s_waitcnt vmcnt(8) lgkmcnt(0)
  s_barrier
  v_mfma_f32_32x32x16_bf16 v[176:191], v[48:51], v[56:59], v[176:191]
  ds_read_b64_tr_b16 v[32:33], v14 offset:16384
  ds_read_b64_tr_b16 v[34:35], v14 offset:17408
  ds_read_b128 v[40:43], v10 offset:16384
  v_mfma_f32_32x32x16_bf16 v[192:207], v[48:51], v[60:63], v[192:207]
  ds_read_b128 v[44:47], v12 offset:16384
  ds_read_b64_tr_b16 v[36:37], v15 offset:16384
  ds_read_b64_tr_b16 v[38:39], v15 offset:17408
  v_mfma_f32_32x32x16_bf16 v[208:223], v[52:55], v[56:59], v[208:223]
  buffer_load_dword v160, v26, s[76:79], 0 offen sc1
  buffer_load_dwordx2 v[152:153], v24, s[80:83], 0 offen sc1
  buffer_load_dwordx2 v[154:155], v25, s[80:83], 0 offen sc1
  v_mfma_f32_32x32x16_bf16 v[224:239], v[52:55], v[60:63], v[224:239]
  buffer_load_dwordx2 v[156:157], v22, s[80:83], 0 offen sc1
  buffer_load_dwordx2 v[158:159], v23, s[80:83], 0 offen sc1
  s_waitcnt lgkmcnt(0)
  v_mfma_f32_32x32x16_bf16 v[176:191], v[32:35], v[40:43], v[176:191]
  ds_read_b64_tr_b16 v[48:49], v14 offset:20480
  ds_read_b64_tr_b16 v[50:51], v14 offset:21504
  ds_read_b128 v[56:59], v11 offset:16384
  v_mfma_f32_32x32x16_bf16 v[192:207], v[32:35], v[44:47], v[192:207]
  ds_read_b128 v[60:63], v13 offset:16384
  ds_read_b64_tr_b16 v[52:53], v15 offset:20480
  ds_read_b64_tr_b16 v[54:55], v15 offset:21504
  v_mfma_f32_32x32x16_bf16 v[208:223], v[36:39], v[40:43], v[208:223]
  buffer_load_ushort v162, v16, s[60:63], 0 offen
  buffer_load_ushort v163, v17, s[60:63], 0 offen
  v_mfma_f32_32x32x16_bf16 v[224:239], v[36:39], v[44:47], v[224:239]
  s_waitcnt vmcnt(11) lgkmcnt(0)
  s_barrier
  v_mfma_f32_32x32x16_bf16 v[176:191], v[48:51], v[56:59], v[176:191]
  ds_read_b64_tr_b16 v[32:33], v14 offset:32768
  ds_read_b64_tr_b16 v[34:35], v14 offset:33792
  ds_read_b128 v[40:43], v10 offset:32768
  v_mfma_f32_32x32x16_bf16 v[192:207], v[48:51], v[60:63], v[192:207]
  ds_read_b128 v[44:47], v12 offset:32768
  ds_read_b64_tr_b16 v[36:37], v15 offset:32768
  ds_read_b64_tr_b16 v[38:39], v15 offset:33792
  v_mfma_f32_32x32x16_bf16 v[208:223], v[52:55], v[56:59], v[208:223]
  v_mfma_f32_32x32x16_bf16 v[224:239], v[52:55], v[60:63], v[224:239]
  s_waitcnt lgkmcnt(0)
  v_mfma_f32_32x32x16_bf16 v[176:191], v[32:35], v[40:43], v[176:191]
  ds_read_b64_tr_b16 v[48:49], v14 offset:36864
  ds_read_b64_tr_b16 v[50:51], v14 offset:37888
  ds_read_b128 v[56:59], v11 offset:32768
  v_mfma_f32_32x32x16_bf16 v[192:207], v[32:35], v[44:47], v[192:207]
  ds_read_b128 v[60:63], v13 offset:32768
  ds_read_b64_tr_b16 v[52:53], v15 offset:36864
  ds_read_b64_tr_b16 v[54:55], v15 offset:37888
  v_mfma_f32_32x32x16_bf16 v[208:223], v[36:39], v[40:43], v[208:223]
  v_mfma_f32_32x32x16_bf16 v[224:239], v[36:39], v[44:47], v[224:239]
  s_waitcnt vmcnt(7) lgkmcnt(0)
  s_barrier
  v_mfma_f32_32x32x16_bf16 v[176:191], v[48:51], v[56:59], v[176:191]
  ds_read_b64_tr_b16 v[32:33], v14 offset:49152
  ds_read_b64_tr_b16 v[34:35], v14 offset:50176
  ds_read_b128 v[40:43], v10 offset:49152
  v_mfma_f32_32x32x16_bf16 v[192:207], v[48:51], v[60:63], v[192:207]
  ds_read_b128 v[44:47], v12 offset:49152
  ds_read_b64_tr_b16 v[36:37], v15 offset:49152
  ds_read_b64_tr_b16 v[38:39], v15 offset:50176
  v_mfma_f32_32x32x16_bf16 v[208:223], v[52:55], v[56:59], v[208:223]
  v_mfma_f32_32x32x16_bf16 v[224:239], v[52:55], v[60:63], v[224:239]
  s_waitcnt lgkmcnt(0)
  v_mfma_f32_32x32x16_bf16 v[176:191], v[32:35], v[40:43], v[176:191]
  ds_read_b64_tr_b16 v[48:49], v14 offset:53248
  ds_read_b64_tr_b16 v[50:51], v14 offset:54272
  ds_read_b128 v[56:59], v11 offset:49152
  v_mfma_f32_32x32x16_bf16 v[192:207], v[32:35], v[44:47], v[192:207]
  ds_read_b128 v[60:63], v13 offset:49152
  ds_read_b64_tr_b16 v[52:53], v15 offset:53248
  ds_read_b64_tr_b16 v[54:55], v15 offset:54272
  v_mfma_f32_32x32x16_bf16 v[208:223], v[36:39], v[40:43], v[208:223]
  v_mfma_f32_32x32x16_bf16 v[224:239], v[36:39], v[44:47], v[224:239]
  s_waitcnt lgkmcnt(0)
  v_mfma_f32_32x32x16_bf16 v[176:191], v[48:51], v[56:59], v[176:191]
  v_mfma_f32_32x32x16_bf16 v[192:207], v[48:51], v[60:63], v[192:207]
  v_mfma_f32_32x32x16_bf16 v[208:223], v[52:55], v[56:59], v[208:223]
  v_mfma_f32_32x32x16_bf16 v[224:239], v[52:55], v[60:63], v[224:239]
g1chk_4:
  s_waitcnt vmcnt(0)
  v_cmp_eq_u32 s[74:75], v160, v153
  v_cmp_eq_u32 vcc, v160, v155
  s_nop 0
  s_and_b64 s[74:75], s[74:75], vcc
  v_cmp_eq_u32 vcc, v160, v157
  s_nop 0
  s_and_b64 s[74:75], s[74:75], vcc
  v_cmp_eq_u32 vcc, v160, v159
  s_nop 0
  s_and_b64 s[74:75], s[74:75], vcc
  v_cmp_ne_u32 vcc, 0, v160
  s_nop 0
  s_and_b64 s[74:75], s[74:75], vcc
  s_cmp_eq_u64 s[74:75], -1
  s_cbranch_scc1 g1ok_5
  s_sleep 8
  buffer_load_dword v160, v26, s[76:79], 0 offen sc1
  buffer_load_dwordx2 v[152:153], v24, s[80:83], 0 offen sc1
  buffer_load_dwordx2 v[154:155], v25, s[80:83], 0 offen sc1
  buffer_load_dwordx2 v[156:157], v22, s[80:83], 0 offen sc1
  buffer_load_dwordx2 v[158:159], v23, s[80:83], 0 offen sc1
  s_branch g1chk_4
g1ok_5:
  v_cmp_gt_u32 vcc, 32, v2
  s_nop 0
  s_mov_b64 s[74:75], vcc
  s_mov_b32 s14, 0x01000100
  v_and_b32 v20, 0xffff0000, v152
  v_rcp_f32 v144, v20
  v_perm_b32 v20, v152, v152, s14
  v_lshrrev_b32 v21, 16, v152
  v_cndmask_b32 v128, 0, v20, s[74:75]
  v_cndmask_b32 v129, 0, v21, s[74:75]
  v_mov_b32 v130, 0
  v_mov_b32 v131, 0
  v_cndmask_b32 v136, 0, v156, s[74:75]
  v_cndmask_b32 v137, 0, v162, s[74:75]
  v_mov_b32 v138, 0
  v_mov_b32 v139, 0
  v_mul_f32 v146, 1069066811, v144
  v_mul_f32 v145, -2.0, v144
  v_and_b32 v20, 0xffff0000, v154
  v_rcp_f32 v148, v20
  v_perm_b32 v20, v154, v154, s14
  v_lshrrev_b32 v21, 16, v154
  v_cndmask_b32 v132, 0, v20, s[74:75]
  v_cndmask_b32 v133, 0, v21, s[74:75]
  v_mov_b32 v134, 0
  v_mov_b32 v135, 0
  v_cndmask_b32 v140, 0, v158, s[74:75]
  v_cndmask_b32 v141, 0, v163, s[74:75]
  v_mov_b32 v142, 0
  v_mov_b32 v143, 0
  v_mul_f32 v150, 1069066811, v148
  v_mul_f32 v149, -2.0, v148
  v_mfma_f32_32x32x16_bf16 v[176:191], v[136:139], v[128:131], v[176:191]
  v_mfma_f32_32x32x16_bf16 v[192:207], v[136:139], v[132:135], v[192:207]
  v_mfma_f32_32x32x16_bf16 v[208:223], v[140:143], v[128:131], v[208:223]
  v_mfma_f32_32x32x16_bf16 v[224:239], v[140:143], v[132:135], v[224:239]
  s_cmp_eq_u32 s7, 13
  s_cselect_b32 s14, s9, 0
  s_cmp_lg_u32 s14, 0
  s_cbranch_scc1 g1end_6
  v_mov_b32 v64, 1.0
  v_mov_b32 v65, 1.0
  v_mov_b32 v66, -2.0
  v_mov_b32 v67, -2.0
  v_bfe_u32 v8, v2, 4, 1
  v_mul_u32_u24 v8, 55296, v8
  v_and_b32 v9, 15, v2
  v_lshl_add_u32 v8, v9, 4, v8
  v_lshl_add_u32 v8, v7, 8, v8
  s_mul_i32 s14, s6, 432
  s_lshl_b32 s73, s7, 2
  s_add_u32 s14, s14, s73
  s_mul_i32 s73, s15, 108
  s_add_u32 s73, s73, s14
  s_add_u32 s73, s73, s67
  s_lshl_b32 s73, s73, 10
  v_pk_mul_f32 v[32:33], v[176:177], v[146:147] op_sel_hi:[1,0]
  v_pk_mul_f32 v[34:35], v[178:179], v[146:147] op_sel_hi:[1,0]
  v_pk_mul_f32 v[36:37], v[180:181], v[146:147] op_sel_hi:[1,0]
  v_pk_mul_f32 v[38:39], v[182:183], v[146:147] op_sel_hi:[1,0]
  v_exp_f32 v32, v32
  v_exp_f32 v33, v33
  v_exp_f32 v34, v34
  v_exp_f32 v35, v35
  v_exp_f32 v36, v36
  v_exp_f32 v37, v37
  v_exp_f32 v38, v38
  v_exp_f32 v39, v39
  v_pk_add_f32 v[32:33], v[32:33], v[64:65]
  v_pk_add_f32 v[34:35], v[34:35], v[64:65]
  v_pk_add_f32 v[36:37], v[36:37], v[64:65]
  v_pk_add_f32 v[38:39], v[38:39], v[64:65]
  v_pk_fma_f32 v[32:33], v[32:33], v[32:33], v[64:65]
  v_pk_fma_f32 v[34:35], v[34:35], v[34:35], v[64:65]
  v_pk_fma_f32 v[36:37], v[36:37], v[36:37], v[64:65]
  v_pk_fma_f32 v[38:39], v[38:39], v[38:39], v[64:65]
  v_rcp_f32 v32, v32
  v_rcp_f32 v33, v33
  v_rcp_f32 v34, v34
  v_rcp_f32 v35, v35
  v_rcp_f32 v36, v36
  v_rcp_f32 v37, v37
  v_rcp_f32 v38, v38
  v_rcp_f32 v39, v39
  v_pk_fma_f32 v[32:33], v[32:33], v[144:145], v[144:145] op_sel:[0,1,0] op_sel_hi:[1,1,0]
  v_pk_fma_f32 v[34:35], v[34:35], v[144:145], v[144:145] op_sel:[0,1,0] op_sel_hi:[1,1,0]
  v_pk_fma_f32 v[36:37], v[36:37], v[144:145], v[144:145] op_sel:[0,1,0] op_sel_hi:[1,1,0]
  v_pk_fma_f32 v[38:39], v[38:39], v[144:145], v[144:145] op_sel:[0,1,0] op_sel_hi:[1,1,0]
  v_pk_mul_f32 v[176:177], v[176:177], v[32:33]
  v_pk_mul_f32 v[178:179], v[178:179], v[34:35]
  v_pk_mul_f32 v[180:181], v[180:181], v[36:37]
  v_pk_mul_f32 v[182:183], v[182:183], v[38:39]
  v_cvt_pk_bf16_f32 v72, v176, v177
  v_cvt_pk_bf16_f32 v73, v178, v179
  v_cvt_pk_bf16_f32 v74, v180, v181
  v_cvt_pk_bf16_f32 v75, v182, v183
  s_nop 0
  v_permlane32_swap_b32 v72, v74
  v_permlane32_swap_b32 v73, v75
  buffer_store_dwordx4 v[72:75], v8, s[56:59], s73 offen offset:0 sc1
  v_pk_mul_f32 v[40:41], v[184:185], v[146:147] op_sel_hi:[1,0]
  v_pk_mul_f32 v[42:43], v[186:187], v[146:147] op_sel_hi:[1,0]
  v_pk_mul_f32 v[44:45], v[188:189], v[146:147] op_sel_hi:[1,0]
  v_pk_mul_f32 v[46:47], v[190:191], v[146:147] op_sel_hi:[1,0]
  v_exp_f32 v40, v40
  v_exp_f32 v41, v41
  v_exp_f32 v42, v42
  v_exp_f32 v43, v43
  v_exp_f32 v44, v44
  v_exp_f32 v45, v45
  v_exp_f32 v46, v46
  v_exp_f32 v47, v47
  v_pk_add_f32 v[40:41], v[40:41], v[64:65]
  v_pk_add_f32 v[42:43], v[42:43], v[64:65]
  v_pk_add_f32 v[44:45], v[44:45], v[64:65]
  v_pk_add_f32 v[46:47], v[46:47], v[64:65]
  v_pk_fma_f32 v[40:41], v[40:41], v[40:41], v[64:65]
  v_pk_fma_f32 v[42:43], v[42:43], v[42:43], v[64:65]
  v_pk_fma_f32 v[44:45], v[44:45], v[44:45], v[64:65]
  v_pk_fma_f32 v[46:47], v[46:47], v[46:47], v[64:65]
  v_rcp_f32 v40, v40
  v_rcp_f32 v41, v41
  v_rcp_f32 v42, v42
  v_rcp_f32 v43, v43
  v_rcp_f32 v44, v44
  v_rcp_f32 v45, v45
  v_rcp_f32 v46, v46
  v_rcp_f32 v47, v47
  v_pk_fma_f32 v[40:41], v[40:41], v[144:145], v[144:145] op_sel:[0,1,0] op_sel_hi:[1,1,0]
  v_pk_fma_f32 v[42:43], v[42:43], v[144:145], v[144:145] op_sel:[0,1,0] op_sel_hi:[1,1,0]
  v_pk_fma_f32 v[44:45], v[44:45], v[144:145], v[144:145] op_sel:[0,1,0] op_sel_hi:[1,1,0]
  v_pk_fma_f32 v[46:47], v[46:47], v[144:145], v[144:145] op_sel:[0,1,0] op_sel_hi:[1,1,0]
  v_pk_mul_f32 v[184:185], v[184:185], v[40:41]
  v_pk_mul_f32 v[186:187], v[186:187], v[42:43]
  v_pk_mul_f32 v[188:189], v[188:189], v[44:45]
  v_pk_mul_f32 v[190:191], v[190:191], v[46:47]
  v_cvt_pk_bf16_f32 v76, v184, v185
  v_cvt_pk_bf16_f32 v77, v186, v187
  v_cvt_pk_bf16_f32 v78, v188, v189
  v_cvt_pk_bf16_f32 v79, v190, v191
  s_nop 0
  v_permlane32_swap_b32 v76, v78
  v_permlane32_swap_b32 v77, v79
  buffer_store_dwordx4 v[76:79], v8, s[56:59], s73 offen offset:512 sc1
  s_mul_i32 s73, s64, 108
  s_add_u32 s73, s73, s14
  s_add_u32 s73, s73, s67
  s_lshl_b32 s73, s73, 10
  v_pk_mul_f32 v[32:33], v[192:193], v[150:151] op_sel_hi:[1,0]
  v_pk_mul_f32 v[34:35], v[194:195], v[150:151] op_sel_hi:[1,0]
  v_pk_mul_f32 v[36:37], v[196:197], v[150:151] op_sel_hi:[1,0]
  v_pk_mul_f32 v[38:39], v[198:199], v[150:151] op_sel_hi:[1,0]
  v_exp_f32 v32, v32
  v_exp_f32 v33, v33
  v_exp_f32 v34, v34
  v_exp_f32 v35, v35
  v_exp_f32 v36, v36
  v_exp_f32 v37, v37
  v_exp_f32 v38, v38
  v_exp_f32 v39, v39
  v_pk_add_f32 v[32:33], v[32:33], v[64:65]
  v_pk_add_f32 v[34:35], v[34:35], v[64:65]
  v_pk_add_f32 v[36:37], v[36:37], v[64:65]
  v_pk_add_f32 v[38:39], v[38:39], v[64:65]
  v_pk_fma_f32 v[32:33], v[32:33], v[32:33], v[64:65]
  v_pk_fma_f32 v[34:35], v[34:35], v[34:35], v[64:65]
  v_pk_fma_f32 v[36:37], v[36:37], v[36:37], v[64:65]
  v_pk_fma_f32 v[38:39], v[38:39], v[38:39], v[64:65]
  v_rcp_f32 v32, v32
  v_rcp_f32 v33, v33
  v_rcp_f32 v34, v34
  v_rcp_f32 v35, v35
  v_rcp_f32 v36, v36
  v_rcp_f32 v37, v37
  v_rcp_f32 v38, v38
  v_rcp_f32 v39, v39
  v_pk_fma_f32 v[32:33], v[32:33], v[148:149], v[148:149] op_sel:[0,1,0] op_sel_hi:[1,1,0]
  v_pk_fma_f32 v[34:35], v[34:35], v[148:149], v[148:149] op_sel:[0,1,0] op_sel_hi:[1,1,0]
  v_pk_fma_f32 v[36:37], v[36:37], v[148:149], v[148:149] op_sel:[0,1,0] op_sel_hi:[1,1,0]
  v_pk_fma_f32 v[38:39], v[38:39], v[148:149], v[148:149] op_sel:[0,1,0] op_sel_hi:[1,1,0]
  v_pk_mul_f32 v[192:193], v[192:193], v[32:33]
  v_pk_mul_f32 v[194:195], v[194:195], v[34:35]
  v_pk_mul_f32 v[196:197], v[196:197], v[36:37]
  v_pk_mul_f32 v[198:199], v[198:199], v[38:39]
  v_cvt_pk_bf16_f32 v80, v192, v193
  v_cvt_pk_bf16_f32 v81, v194, v195
  v_cvt_pk_bf16_f32 v82, v196, v197
  v_cvt_pk_bf16_f32 v83, v198, v199
  s_nop 0
  v_permlane32_swap_b32 v80, v82
  v_permlane32_swap_b32 v81, v83
  buffer_store_dwordx4 v[80:83], v8, s[56:59], s73 offen offset:0 sc1
  v_pk_mul_f32 v[40:41], v[200:201], v[150:151] op_sel_hi:[1,0]
  v_pk_mul_f32 v[42:43], v[202:203], v[150:151] op_sel_hi:[1,0]
  v_pk_mul_f32 v[44:45], v[204:205], v[150:151] op_sel_hi:[1,0]
  v_pk_mul_f32 v[46:47], v[206:207], v[150:151] op_sel_hi:[1,0]
  v_exp_f32 v40, v40
  v_exp_f32 v41, v41
  v_exp_f32 v42, v42
  v_exp_f32 v43, v43
  v_exp_f32 v44, v44
  v_exp_f32 v45, v45
  v_exp_f32 v46, v46
  v_exp_f32 v47, v47
  v_pk_add_f32 v[40:41], v[40:41], v[64:65]
  v_pk_add_f32 v[42:43], v[42:43], v[64:65]
  v_pk_add_f32 v[44:45], v[44:45], v[64:65]
  v_pk_add_f32 v[46:47], v[46:47], v[64:65]
  v_pk_fma_f32 v[40:41], v[40:41], v[40:41], v[64:65]
  v_pk_fma_f32 v[42:43], v[42:43], v[42:43], v[64:65]
  v_pk_fma_f32 v[44:45], v[44:45], v[44:45], v[64:65]
  v_pk_fma_f32 v[46:47], v[46:47], v[46:47], v[64:65]
  v_rcp_f32 v40, v40
  v_rcp_f32 v41, v41
  v_rcp_f32 v42, v42
  v_rcp_f32 v43, v43
  v_rcp_f32 v44, v44
  v_rcp_f32 v45, v45
  v_rcp_f32 v46, v46
  v_rcp_f32 v47, v47
  v_pk_fma_f32 v[40:41], v[40:41], v[148:149], v[148:149] op_sel:[0,1,0] op_sel_hi:[1,1,0]
  v_pk_fma_f32 v[42:43], v[42:43], v[148:149], v[148:149] op_sel:[0,1,0] op_sel_hi:[1,1,0]
  v_pk_fma_f32 v[44:45], v[44:45], v[148:149], v[148:149] op_sel:[0,1,0] op_sel_hi:[1,1,0]
  v_pk_fma_f32 v[46:47], v[46:47], v[148:149], v[148:149] op_sel:[0,1,0] op_sel_hi:[1,1,0]
  v_pk_mul_f32 v[200:201], v[200:201], v[40:41]
  v_pk_mul_f32 v[202:203], v[202:203], v[42:43]
  v_pk_mul_f32 v[204:205], v[204:205], v[44:45]
  v_pk_mul_f32 v[206:207], v[206:207], v[46:47]
  v_cvt_pk_bf16_f32 v84, v200, v201
  v_cvt_pk_bf16_f32 v85, v202, v203
  v_cvt_pk_bf16_f32 v86, v204, v205
  v_cvt_pk_bf16_f32 v87, v206, v207
  s_nop 0
  v_permlane32_swap_b32 v84, v86
  v_permlane32_swap_b32 v85, v87
  buffer_store_dwordx4 v[84:87], v8, s[56:59], s73 offen offset:512 sc1
  s_mul_i32 s73, s15, 108
  s_add_u32 s73, s73, s14
  s_add_u32 s73, s73, s68
  s_lshl_b32 s73, s73, 10
  v_pk_mul_f32 v[32:33], v[208:209], v[146:147] op_sel_hi:[1,0]
  v_pk_mul_f32 v[34:35], v[210:211], v[146:147] op_sel_hi:[1,0]
  v_pk_mul_f32 v[36:37], v[212:213], v[146:147] op_sel_hi:[1,0]
  v_pk_mul_f32 v[38:39], v[214:215], v[146:147] op_sel_hi:[1,0]
  v_exp_f32 v32, v32
  v_exp_f32 v33, v33
  v_exp_f32 v34, v34
  v_exp_f32 v35, v35
  v_exp_f32 v36, v36
  v_exp_f32 v37, v37
  v_exp_f32 v38, v38
  v_exp_f32 v39, v39
  v_pk_add_f32 v[32:33], v[32:33], v[64:65]
  v_pk_add_f32 v[34:35], v[34:35], v[64:65]
  v_pk_add_f32 v[36:37], v[36:37], v[64:65]
  v_pk_add_f32 v[38:39], v[38:39], v[64:65]
  v_pk_fma_f32 v[32:33], v[32:33], v[32:33], v[64:65]
  v_pk_fma_f32 v[34:35], v[34:35], v[34:35], v[64:65]
  v_pk_fma_f32 v[36:37], v[36:37], v[36:37], v[64:65]
  v_pk_fma_f32 v[38:39], v[38:39], v[38:39], v[64:65]
  v_rcp_f32 v32, v32
  v_rcp_f32 v33, v33
  v_rcp_f32 v34, v34
  v_rcp_f32 v35, v35
  v_rcp_f32 v36, v36
  v_rcp_f32 v37, v37
  v_rcp_f32 v38, v38
  v_rcp_f32 v39, v39
  v_pk_fma_f32 v[32:33], v[32:33], v[144:145], v[144:145] op_sel:[0,1,0] op_sel_hi:[1,1,0]
  v_pk_fma_f32 v[34:35], v[34:35], v[144:145], v[144:145] op_sel:[0,1,0] op_sel_hi:[1,1,0]
  v_pk_fma_f32 v[36:37], v[36:37], v[144:145], v[144:145] op_sel:[0,1,0] op_sel_hi:[1,1,0]
  v_pk_fma_f32 v[38:39], v[38:39], v[144:145], v[144:145] op_sel:[0,1,0] op_sel_hi:[1,1,0]
  v_pk_mul_f32 v[208:209], v[208:209], v[32:33]
  v_pk_mul_f32 v[210:211], v[210:211], v[34:35]
  v_pk_mul_f32 v[212:213], v[212:213], v[36:37]
  v_pk_mul_f32 v[214:215], v[214:215], v[38:39]
  v_cvt_pk_bf16_f32 v72, v208, v209
  v_cvt_pk_bf16_f32 v73, v210, v211
  v_cvt_pk_bf16_f32 v74, v212, v213
  v_cvt_pk_bf16_f32 v75, v214, v215
  s_nop 0
  v_permlane32_swap_b32 v72, v74
  v_permlane32_swap_b32 v73, v75
  buffer_store_dwordx4 v[72:75], v8, s[56:59], s73 offen offset:0 sc1
  v_pk_mul_f32 v[40:41], v[216:217], v[146:147] op_sel_hi:[1,0]
  v_pk_mul_f32 v[42:43], v[218:219], v[146:147] op_sel_hi:[1,0]
  v_pk_mul_f32 v[44:45], v[220:221], v[146:147] op_sel_hi:[1,0]
  v_pk_mul_f32 v[46:47], v[222:223], v[146:147] op_sel_hi:[1,0]
  v_exp_f32 v40, v40
  v_exp_f32 v41, v41
  v_exp_f32 v42, v42
  v_exp_f32 v43, v43
  v_exp_f32 v44, v44
  v_exp_f32 v45, v45
  v_exp_f32 v46, v46
  v_exp_f32 v47, v47
  v_pk_add_f32 v[40:41], v[40:41], v[64:65]
  v_pk_add_f32 v[42:43], v[42:43], v[64:65]
  v_pk_add_f32 v[44:45], v[44:45], v[64:65]
  v_pk_add_f32 v[46:47], v[46:47], v[64:65]
  v_pk_fma_f32 v[40:41], v[40:41], v[40:41], v[64:65]
  v_pk_fma_f32 v[42:43], v[42:43], v[42:43], v[64:65]
  v_pk_fma_f32 v[44:45], v[44:45], v[44:45], v[64:65]
  v_pk_fma_f32 v[46:47], v[46:47], v[46:47], v[64:65]
  v_rcp_f32 v40, v40
  v_rcp_f32 v41, v41
  v_rcp_f32 v42, v42
  v_rcp_f32 v43, v43
  v_rcp_f32 v44, v44
  v_rcp_f32 v45, v45
  v_rcp_f32 v46, v46
  v_rcp_f32 v47, v47
  v_pk_fma_f32 v[40:41], v[40:41], v[144:145], v[144:145] op_sel:[0,1,0] op_sel_hi:[1,1,0]
  v_pk_fma_f32 v[42:43], v[42:43], v[144:145], v[144:145] op_sel:[0,1,0] op_sel_hi:[1,1,0]
  v_pk_fma_f32 v[44:45], v[44:45], v[144:145], v[144:145] op_sel:[0,1,0] op_sel_hi:[1,1,0]
  v_pk_fma_f32 v[46:47], v[46:47], v[144:145], v[144:145] op_sel:[0,1,0] op_sel_hi:[1,1,0]
  v_pk_mul_f32 v[216:217], v[216:217], v[40:41]
  v_pk_mul_f32 v[218:219], v[218:219], v[42:43]
  v_pk_mul_f32 v[220:221], v[220:221], v[44:45]
  v_pk_mul_f32 v[222:223], v[222:223], v[46:47]
  v_cvt_pk_bf16_f32 v76, v216, v217
  v_cvt_pk_bf16_f32 v77, v218, v219
  v_cvt_pk_bf16_f32 v78, v220, v221
  v_cvt_pk_bf16_f32 v79, v222, v223
  s_nop 0
  v_permlane32_swap_b32 v76, v78
  v_permlane32_swap_b32 v77, v79
  buffer_store_dwordx4 v[76:79], v8, s[56:59], s73 offen offset:512 sc1
  s_mul_i32 s73, s64, 108
  s_add_u32 s73, s73, s14
  s_add_u32 s73, s73, s68
  s_lshl_b32 s73, s73, 10
  v_pk_mul_f32 v[32:33], v[224:225], v[150:151] op_sel_hi:[1,0]
  v_pk_mul_f32 v[34:35], v[226:227], v[150:151] op_sel_hi:[1,0]
  v_pk_mul_f32 v[36:37], v[228:229], v[150:151] op_sel_hi:[1,0]
  v_pk_mul_f32 v[38:39], v[230:231], v[150:151] op_sel_hi:[1,0]
  v_exp_f32 v32, v32
  v_exp_f32 v33, v33
  v_exp_f32 v34, v34
  v_exp_f32 v35, v35
  v_exp_f32 v36, v36
  v_exp_f32 v37, v37
  v_exp_f32 v38, v38
  v_exp_f32 v39, v39
  v_pk_add_f32 v[32:33], v[32:33], v[64:65]
  v_pk_add_f32 v[34:35], v[34:35], v[64:65]
  v_pk_add_f32 v[36:37], v[36:37], v[64:65]
  v_pk_add_f32 v[38:39], v[38:39], v[64:65]
  v_pk_fma_f32 v[32:33], v[32:33], v[32:33], v[64:65]
  v_pk_fma_f32 v[34:35], v[34:35], v[34:35], v[64:65]
  v_pk_fma_f32 v[36:37], v[36:37], v[36:37], v[64:65]
  v_pk_fma_f32 v[38:39], v[38:39], v[38:39], v[64:65]
  v_rcp_f32 v32, v32
  v_rcp_f32 v33, v33
  v_rcp_f32 v34, v34
  v_rcp_f32 v35, v35
  v_rcp_f32 v36, v36
  v_rcp_f32 v37, v37
  v_rcp_f32 v38, v38
  v_rcp_f32 v39, v39
  v_pk_fma_f32 v[32:33], v[32:33], v[148:149], v[148:149] op_sel:[0,1,0] op_sel_hi:[1,1,0]
  v_pk_fma_f32 v[34:35], v[34:35], v[148:149], v[148:149] op_sel:[0,1,0] op_sel_hi:[1,1,0]
  v_pk_fma_f32 v[36:37], v[36:37], v[148:149], v[148:149] op_sel:[0,1,0] op_sel_hi:[1,1,0]
  v_pk_fma_f32 v[38:39], v[38:39], v[148:149], v[148:149] op_sel:[0,1,0] op_sel_hi:[1,1,0]
  v_pk_mul_f32 v[224:225], v[224:225], v[32:33]
  v_pk_mul_f32 v[226:227], v[226:227], v[34:35]
  v_pk_mul_f32 v[228:229], v[228:229], v[36:37]
  v_pk_mul_f32 v[230:231], v[230:231], v[38:39]
  v_cvt_pk_bf16_f32 v80, v224, v225
  v_cvt_pk_bf16_f32 v81, v226, v227
  v_cvt_pk_bf16_f32 v82, v228, v229
  v_cvt_pk_bf16_f32 v83, v230, v231
  s_nop 0
  v_permlane32_swap_b32 v80, v82
  v_permlane32_swap_b32 v81, v83
  buffer_store_dwordx4 v[80:83], v8, s[56:59], s73 offen offset:0 sc1
  v_pk_mul_f32 v[40:41], v[232:233], v[150:151] op_sel_hi:[1,0]
  v_pk_mul_f32 v[42:43], v[234:235], v[150:151] op_sel_hi:[1,0]
  v_pk_mul_f32 v[44:45], v[236:237], v[150:151] op_sel_hi:[1,0]
  v_pk_mul_f32 v[46:47], v[238:239], v[150:151] op_sel_hi:[1,0]
  v_exp_f32 v40, v40
  v_exp_f32 v41, v41
  v_exp_f32 v42, v42
  v_exp_f32 v43, v43
  v_exp_f32 v44, v44
  v_exp_f32 v45, v45
  v_exp_f32 v46, v46
  v_exp_f32 v47, v47
  v_pk_add_f32 v[40:41], v[40:41], v[64:65]
  v_pk_add_f32 v[42:43], v[42:43], v[64:65]
  v_pk_add_f32 v[44:45], v[44:45], v[64:65]
  v_pk_add_f32 v[46:47], v[46:47], v[64:65]
  v_pk_fma_f32 v[40:41], v[40:41], v[40:41], v[64:65]
  v_pk_fma_f32 v[42:43], v[42:43], v[42:43], v[64:65]
  v_pk_fma_f32 v[44:45], v[44:45], v[44:45], v[64:65]
  v_pk_fma_f32 v[46:47], v[46:47], v[46:47], v[64:65]
  v_rcp_f32 v40, v40
  v_rcp_f32 v41, v41
  v_rcp_f32 v42, v42
  v_rcp_f32 v43, v43
  v_rcp_f32 v44, v44
  v_rcp_f32 v45, v45
  v_rcp_f32 v46, v46
  v_rcp_f32 v47, v47
  v_pk_fma_f32 v[40:41], v[40:41], v[148:149], v[148:149] op_sel:[0,1,0] op_sel_hi:[1,1,0]
  v_pk_fma_f32 v[42:43], v[42:43], v[148:149], v[148:149] op_sel:[0,1,0] op_sel_hi:[1,1,0]
  v_pk_fma_f32 v[44:45], v[44:45], v[148:149], v[148:149] op_sel:[0,1,0] op_sel_hi:[1,1,0]
  v_pk_fma_f32 v[46:47], v[46:47], v[148:149], v[148:149] op_sel:[0,1,0] op_sel_hi:[1,1,0]
  v_pk_mul_f32 v[232:233], v[232:233], v[40:41]
  v_pk_mul_f32 v[234:235], v[234:235], v[42:43]
  v_pk_mul_f32 v[236:237], v[236:237], v[44:45]
  v_pk_mul_f32 v[238:239], v[238:239], v[46:47]
  v_cvt_pk_bf16_f32 v84, v232, v233
  v_cvt_pk_bf16_f32 v85, v234, v235
  v_cvt_pk_bf16_f32 v86, v236, v237
  v_cvt_pk_bf16_f32 v87, v238, v239
  s_nop 0
  v_permlane32_swap_b32 v84, v86
  v_permlane32_swap_b32 v85, v87
  buffer_store_dwordx4 v[84:87], v8, s[56:59], s73 offen offset:512 sc1
g1end_6:
  s_endpgm
l1_kernel_r1:
  s_sub_u32 s3, s2, 224
  s_waitcnt lgkmcnt(0)
l1_lnt_entry:
  s_mov_b32 s60, s3
  s_and_b32 s4, s3, 3
  s_lshl_b32 s4, s4, 4
  s_lshr_b32 s5, s3, 3
  s_lshl_b32 s5, s5, 1
  s_add_u32 s4, s4, s5
  s_bfe_u32 s5, s3, 0x10002
  s_add_u32 s3, s4, s5
  s_mov_b32 s48, s16
  s_mov_b32 s49, s17
  s_mov_b32 s50, 2621440
  s_mov_b32 s51, 0x20000
  s_mov_b32 s52, s46
  s_mov_b32 s53, s47
  s_mov_b32 s54, 2621440
  s_mov_b32 s55, 0x20000
  s_lshl_b32 s4, s3, 5
  v_and_b32 v2, 63, v0
  v_lshrrev_b32 v3, 6, v0
  v_lshrrev_b32 v4, 3, v0
  v_and_b32 v5, 7, v0
  v_lshlrev_b32 v5, 4, v5
  v_add_u32 v6, s4, v4
  v_mul_u32_u24 v6, 1280, v6
  v_add_u32 v6, v6, v5
  buffer_load_dwordx4 v[16:19], v6, s[48:51], 0 offen offset:0
  buffer_load_dwordx4 v[20:23], v6, s[48:51], 0 offen offset:128
  buffer_load_dwordx4 v[24:27], v6, s[48:51], 0 offen offset:256
  buffer_load_dwordx4 v[28:31], v6, s[48:51], 0 offen offset:384
  buffer_load_dwordx4 v[32:35], v6, s[48:51], 0 offen offset:512
  buffer_load_dwordx4 v[36:39], v6, s[48:51], 0 offen offset:640
  buffer_load_dwordx4 v[40:43], v6, s[48:51], 0 offen offset:768
  buffer_load_dwordx4 v[44:47], v6, s[48:51], 0 offen offset:896
  buffer_load_dwordx4 v[48:51], v6, s[48:51], 0 offen offset:1024
  buffer_load_dwordx4 v[52:55], v6, s[48:51], 0 offen offset:1152
  v_mul_u32_u24 v1, 1296, v4
  v_add_u32 v1, v1, v5
  s_mov_b32 s12, s44
  s_mov_b32 s13, s45
  s_mov_b32 s14, 256
  s_mov_b32 s15, 0x20000
  s_memrealtime s[62:63]
  s_waitcnt lgkmcnt(0)
  s_or_b32 s62, s62, 1
  v_mov_b32 v200, s62
  v_mov_b32 v201, 0
  v_mov_b32 v202, 0
  v_cmp_eq_u32 vcc, 0, v0
  s_nop 0
  s_and_saveexec_b64 s[8:9], vcc
  s_cbranch_execz nn_7
  buffer_atomic_cmpswap v[200:201], v202, s[12:15], 0 offen sc0 sc1
nn_7:
  s_mov_b64 exec, s[8:9]
  s_mov_b32 s5, 0x3f803f80
  v_mov_b32 v7, 0
  v_mov_b32 v8, 0
  s_waitcnt vmcnt(9)
  v_dot2_f32_bf16 v7, v16, s5, v7
  v_dot2_f32_bf16 v8, v17, s5, v8
  v_dot2_f32_bf16 v7, v18, s5, v7
  v_dot2_f32_bf16 v8, v19, s5, v8
  s_waitcnt vmcnt(8)
  v_dot2_f32_bf16 v7, v20, s5, v7
  v_dot2_f32_bf16 v8, v21, s5, v8
  v_dot2_f32_bf16 v7, v22, s5, v7
  v_dot2_f32_bf16 v8, v23, s5, v8
  s_waitcnt vmcnt(7)
  v_dot2_f32_bf16 v7, v24, s5, v7
  v_dot2_f32_bf16 v8, v25, s5, v8
  v_dot2_f32_bf16 v7, v26, s5, v7
  v_dot2_f32_bf16 v8, v27, s5, v8
  s_waitcnt vmcnt(6)
  v_dot2_f32_bf16 v7, v28, s5, v7
  v_dot2_f32_bf16 v8, v29, s5, v8
  v_dot2_f32_bf16 v7, v30, s5, v7
  v_dot2_f32_bf16 v8, v31, s5, v8
  s_waitcnt vmcnt(5)
  v_dot2_f32_bf16 v7, v32, s5, v7
  v_dot2_f32_bf16 v8, v33, s5, v8
  v_dot2_f32_bf16 v7, v34, s5, v7
  v_dot2_f32_bf16 v8, v35, s5, v8
  s_waitcnt vmcnt(4)
  v_dot2_f32_bf16 v7, v36, s5, v7
  v_dot2_f32_bf16 v8, v37, s5, v8
  v_dot2_f32_bf16 v7, v38, s5, v7
  v_dot2_f32_bf16 v8, v39, s5, v8
  s_waitcnt vmcnt(3)
  v_dot2_f32_bf16 v7, v40, s5, v7
  v_dot2_f32_bf16 v8, v41, s5, v8
  v_dot2_f32_bf16 v7, v42, s5, v7
  v_dot2_f32_bf16 v8, v43, s5, v8
  s_waitcnt vmcnt(2)
  v_dot2_f32_bf16 v7, v44, s5, v7
  v_dot2_f32_bf16 v8, v45, s5, v8
  v_dot2_f32_bf16 v7, v46, s5, v7
  v_dot2_f32_bf16 v8, v47, s5, v8
  s_waitcnt vmcnt(1)
  v_dot2_f32_bf16 v7, v48, s5, v7
  v_dot2_f32_bf16 v8, v49, s5, v8
  v_dot2_f32_bf16 v7, v50, s5, v7
  v_dot2_f32_bf16 v8, v51, s5, v8
  s_waitcnt vmcnt(0)
  v_dot2_f32_bf16 v7, v52, s5, v7
  v_dot2_f32_bf16 v8, v53, s5, v8
  v_dot2_f32_bf16 v7, v54, s5, v7
  v_dot2_f32_bf16 v8, v55, s5, v8
  s_nop 2
  v_add_f32 v7, v7, v8
  s_nop 1
  v_add_f32_dpp v7, v7, v7 quad_perm:[1,0,3,2] row_mask:0xf bank_mask:0xf
  s_nop 1
  v_add_f32_dpp v7, v7, v7 quad_perm:[2,3,0,1] row_mask:0xf bank_mask:0xf
  s_nop 1
  v_add_f32_dpp v7, v7, v7 row_half_mirror row_mask:0xf bank_mask:0xf
  s_mov_b32 s6, 0x3acccccd
  v_mul_f32 v7, s6, v7
  v_mov_b32 v8, 0
  v_mov_b32 v9, 0
  v_mov_b32 v12, 0
  v_mov_b32 v13, 0
  v_sub_f32 v14, 0, v7
  v_lshlrev_b32 v64, 16, v16
  v_and_b32 v65, 0xffff0000, v16
  v_pk_add_f32 v[144:145], v[64:65], v[14:15] op_sel_hi:[1,0]
  v_pk_fma_f32 v[12:13], v[144:145], v[144:145], v[12:13]
  v_lshlrev_b32 v66, 16, v17
  v_and_b32 v67, 0xffff0000, v17
  v_pk_add_f32 v[10:11], v[66:67], v[14:15] op_sel_hi:[1,0]
  v_pk_fma_f32 v[8:9], v[10:11], v[10:11], v[8:9]
  v_lshlrev_b32 v68, 16, v18
  v_and_b32 v69, 0xffff0000, v18
  v_pk_add_f32 v[144:145], v[68:69], v[14:15] op_sel_hi:[1,0]
  v_pk_fma_f32 v[12:13], v[144:145], v[144:145], v[12:13]
  v_lshlrev_b32 v70, 16, v19
  v_and_b32 v71, 0xffff0000, v19
  v_pk_add_f32 v[10:11], v[70:71], v[14:15] op_sel_hi:[1,0]
  v_pk_fma_f32 v[8:9], v[10:11], v[10:11], v[8:9]
  v_lshlrev_b32 v72, 16, v20
  v_and_b32 v73, 0xffff0000, v20
  v_pk_add_f32 v[144:145], v[72:73], v[14:15] op_sel_hi:[1,0]
  v_pk_fma_f32 v[12:13], v[144:145], v[144:145], v[12:13]
  v_lshlrev_b32 v74, 16, v21
  v_and_b32 v75, 0xffff0000, v21
  v_pk_add_f32 v[10:11], v[74:75], v[14:15] op_sel_hi:[1,0]
  v_pk_fma_f32 v[8:9], v[10:11], v[10:11], v[8:9]
  v_lshlrev_b32 v76, 16, v22
  v_and_b32 v77, 0xffff0000, v22
  v_pk_add_f32 v[144:145], v[76:77], v[14:15] op_sel_hi:[1,0]
  v_pk_fma_f32 v[12:13], v[144:145], v[144:145], v[12:13]
  v_lshlrev_b32 v78, 16, v23
  v_and_b32 v79, 0xffff0000, v23
  v_pk_add_f32 v[10:11], v[78:79], v[14:15] op_sel_hi:[1,0]
  v_pk_fma_f32 v[8:9], v[10:11], v[10:11], v[8:9]
  v_lshlrev_b32 v80, 16, v24
  v_and_b32 v81, 0xffff0000, v24
  v_pk_add_f32 v[144:145], v[80:81], v[14:15] op_sel_hi:[1,0]
  v_pk_fma_f32 v[12:13], v[144:145], v[144:145], v[12:13]
  v_lshlrev_b32 v82, 16, v25
  v_and_b32 v83, 0xffff0000, v25
  v_pk_add_f32 v[10:11], v[82:83], v[14:15] op_sel_hi:[1,0]
  v_pk_fma_f32 v[8:9], v[10:11], v[10:11], v[8:9]
  v_lshlrev_b32 v84, 16, v26
  v_and_b32 v85, 0xffff0000, v26
  v_pk_add_f32 v[144:145], v[84:85], v[14:15] op_sel_hi:[1,0]
  v_pk_fma_f32 v[12:13], v[144:145], v[144:145], v[12:13]
  v_lshlrev_b32 v86, 16, v27
  v_and_b32 v87, 0xffff0000, v27
  v_pk_add_f32 v[10:11], v[86:87], v[14:15] op_sel_hi:[1,0]
  v_pk_fma_f32 v[8:9], v[10:11], v[10:11], v[8:9]
  v_lshlrev_b32 v88, 16, v28
  v_and_b32 v89, 0xffff0000, v28
  v_pk_add_f32 v[144:145], v[88:89], v[14:15] op_sel_hi:[1,0]
  v_pk_fma_f32 v[12:13], v[144:145], v[144:145], v[12:13]
  v_lshlrev_b32 v90, 16, v29
  v_and_b32 v91, 0xffff0000, v29
  v_pk_add_f32 v[10:11], v[90:91], v[14:15] op_sel_hi:[1,0]
  v_pk_fma_f32 v[8:9], v[10:11], v[10:11], v[8:9]
  v_lshlrev_b32 v92, 16, v30
  v_and_b32 v93, 0xffff0000, v30
  v_pk_add_f32 v[144:145], v[92:93], v[14:15] op_sel_hi:[1,0]
  v_pk_fma_f32 v[12:13], v[144:145], v[144:145], v[12:13]
  v_lshlrev_b32 v94, 16, v31
  v_and_b32 v95, 0xffff0000, v31
  v_pk_add_f32 v[10:11], v[94:95], v[14:15] op_sel_hi:[1,0]
  v_pk_fma_f32 v[8:9], v[10:11], v[10:11], v[8:9]
  v_lshlrev_b32 v96, 16, v32
  v_and_b32 v97, 0xffff0000, v32
  v_pk_add_f32 v[144:145], v[96:97], v[14:15] op_sel_hi:[1,0]
  v_pk_fma_f32 v[12:13], v[144:145], v[144:145], v[12:13]
  v_lshlrev_b32 v98, 16, v33
  v_and_b32 v99, 0xffff0000, v33
  v_pk_add_f32 v[10:11], v[98:99], v[14:15] op_sel_hi:[1,0]
  v_pk_fma_f32 v[8:9], v[10:11], v[10:11], v[8:9]
  v_lshlrev_b32 v100, 16, v34
  v_and_b32 v101, 0xffff0000, v34
  v_pk_add_f32 v[144:145], v[100:101], v[14:15] op_sel_hi:[1,0]
  v_pk_fma_f32 v[12:13], v[144:145], v[144:145], v[12:13]
  v_lshlrev_b32 v102, 16, v35
  v_and_b32 v103, 0xffff0000, v35
  v_pk_add_f32 v[10:11], v[102:103], v[14:15] op_sel_hi:[1,0]
  v_pk_fma_f32 v[8:9], v[10:11], v[10:11], v[8:9]
  v_lshlrev_b32 v104, 16, v36
  v_and_b32 v105, 0xffff0000, v36
  v_pk_add_f32 v[144:145], v[104:105], v[14:15] op_sel_hi:[1,0]
  v_pk_fma_f32 v[12:13], v[144:145], v[144:145], v[12:13]
  v_lshlrev_b32 v106, 16, v37
  v_and_b32 v107, 0xffff0000, v37
  v_pk_add_f32 v[10:11], v[106:107], v[14:15] op_sel_hi:[1,0]
  v_pk_fma_f32 v[8:9], v[10:11], v[10:11], v[8:9]
  v_lshlrev_b32 v108, 16, v38
  v_and_b32 v109, 0xffff0000, v38
  v_pk_add_f32 v[144:145], v[108:109], v[14:15] op_sel_hi:[1,0]
  v_pk_fma_f32 v[12:13], v[144:145], v[144:145], v[12:13]
  v_lshlrev_b32 v110, 16, v39
  v_and_b32 v111, 0xffff0000, v39
  v_pk_add_f32 v[10:11], v[110:111], v[14:15] op_sel_hi:[1,0]
  v_pk_fma_f32 v[8:9], v[10:11], v[10:11], v[8:9]
  v_lshlrev_b32 v112, 16, v40
  v_and_b32 v113, 0xffff0000, v40
  v_pk_add_f32 v[144:145], v[112:113], v[14:15] op_sel_hi:[1,0]
  v_pk_fma_f32 v[12:13], v[144:145], v[144:145], v[12:13]
  v_lshlrev_b32 v114, 16, v41
  v_and_b32 v115, 0xffff0000, v41
  v_pk_add_f32 v[10:11], v[114:115], v[14:15] op_sel_hi:[1,0]
  v_pk_fma_f32 v[8:9], v[10:11], v[10:11], v[8:9]
  v_lshlrev_b32 v116, 16, v42
  v_and_b32 v117, 0xffff0000, v42
  v_pk_add_f32 v[144:145], v[116:117], v[14:15] op_sel_hi:[1,0]
  v_pk_fma_f32 v[12:13], v[144:145], v[144:145], v[12:13]
  v_lshlrev_b32 v118, 16, v43
  v_and_b32 v119, 0xffff0000, v43
  v_pk_add_f32 v[10:11], v[118:119], v[14:15] op_sel_hi:[1,0]
  v_pk_fma_f32 v[8:9], v[10:11], v[10:11], v[8:9]
  v_lshlrev_b32 v120, 16, v44
  v_and_b32 v121, 0xffff0000, v44
  v_pk_add_f32 v[144:145], v[120:121], v[14:15] op_sel_hi:[1,0]
  v_pk_fma_f32 v[12:13], v[144:145], v[144:145], v[12:13]
  v_lshlrev_b32 v122, 16, v45
  v_and_b32 v123, 0xffff0000, v45
  v_pk_add_f32 v[10:11], v[122:123], v[14:15] op_sel_hi:[1,0]
  v_pk_fma_f32 v[8:9], v[10:11], v[10:11], v[8:9]
  v_lshlrev_b32 v124, 16, v46
  v_and_b32 v125, 0xffff0000, v46
  v_pk_add_f32 v[144:145], v[124:125], v[14:15] op_sel_hi:[1,0]
  v_pk_fma_f32 v[12:13], v[144:145], v[144:145], v[12:13]
  v_lshlrev_b32 v126, 16, v47
  v_and_b32 v127, 0xffff0000, v47
  v_pk_add_f32 v[10:11], v[126:127], v[14:15] op_sel_hi:[1,0]
  v_pk_fma_f32 v[8:9], v[10:11], v[10:11], v[8:9]
  v_lshlrev_b32 v128, 16, v48
  v_and_b32 v129, 0xffff0000, v48
  v_pk_add_f32 v[144:145], v[128:129], v[14:15] op_sel_hi:[1,0]
  v_pk_fma_f32 v[12:13], v[144:145], v[144:145], v[12:13]
  v_lshlrev_b32 v130, 16, v49
  v_and_b32 v131, 0xffff0000, v49
  v_pk_add_f32 v[10:11], v[130:131], v[14:15] op_sel_hi:[1,0]
  v_pk_fma_f32 v[8:9], v[10:11], v[10:11], v[8:9]
  v_lshlrev_b32 v132, 16, v50
  v_and_b32 v133, 0xffff0000, v50
  v_pk_add_f32 v[144:145], v[132:133], v[14:15] op_sel_hi:[1,0]
  v_pk_fma_f32 v[12:13], v[144:145], v[144:145], v[12:13]
  v_lshlrev_b32 v134, 16, v51
  v_and_b32 v135, 0xffff0000, v51
  v_pk_add_f32 v[10:11], v[134:135], v[14:15] op_sel_hi:[1,0]
  v_pk_fma_f32 v[8:9], v[10:11], v[10:11], v[8:9]
  v_lshlrev_b32 v136, 16, v52
  v_and_b32 v137, 0xffff0000, v52
  v_pk_add_f32 v[144:145], v[136:137], v[14:15] op_sel_hi:[1,0]
  v_pk_fma_f32 v[12:13], v[144:145], v[144:145], v[12:13]
  v_lshlrev_b32 v138, 16, v53
  v_and_b32 v139, 0xffff0000, v53
  v_pk_add_f32 v[10:11], v[138:139], v[14:15] op_sel_hi:[1,0]
  v_pk_fma_f32 v[8:9], v[10:11], v[10:11], v[8:9]
  v_lshlrev_b32 v140, 16, v54
  v_and_b32 v141, 0xffff0000, v54
  v_pk_add_f32 v[144:145], v[140:141], v[14:15] op_sel_hi:[1,0]
  v_pk_fma_f32 v[12:13], v[144:145], v[144:145], v[12:13]
  v_lshlrev_b32 v142, 16, v55
  v_and_b32 v143, 0xffff0000, v55
  v_pk_add_f32 v[10:11], v[142:143], v[14:15] op_sel_hi:[1,0]
  v_pk_fma_f32 v[8:9], v[10:11], v[10:11], v[8:9]
  v_pk_add_f32 v[8:9], v[8:9], v[12:13]
  v_add_f32 v8, v8, v9
  s_nop 1
  v_add_f32_dpp v8, v8, v8 quad_perm:[1,0,3,2] row_mask:0xf bank_mask:0xf
  s_nop 1
  v_add_f32_dpp v8, v8, v8 quad_perm:[2,3,0,1] row_mask:0xf bank_mask:0xf
  s_nop 1
  v_add_f32_dpp v8, v8, v8 row_half_mirror row_mask:0xf bank_mask:0xf
  v_mul_f32 v8, s6, v8
  v_cvt_pk_bf16_f32 v9, v7, v8
  v_lshlrev_b32 v7, 16, v9
  v_and_b32 v8, 0xffff0000, v9
  v_add_f32 v8, 0x3727c5ac, v8
  v_cvt_pk_bf16_f32 v8, v8, v8
  v_lshlrev_b32 v8, 16, v8
  v_sqrt_f32 v8, v8
  s_nop 0
  v_cvt_pk_bf16_f32 v8, v8, v8
  v_lshlrev_b32 v8, 16, v8
  v_rcp_f32 v9, v8
  s_waitcnt vmcnt(0)
  v_mov_b32 v201, s62
  v_cmp_eq_u32 vcc, 0, v200
  s_nop 1
  v_cndmask_b32 v200, v200, v201, vcc
  v_cmp_eq_u32 vcc, 0, v0
  s_nop 0
  s_and_saveexec_b64 s[8:9], vcc
  ds_write_b32 v202, v200 offset:60000
  s_mov_b64 exec, s[8:9]
  s_waitcnt lgkmcnt(0)
  s_barrier
  ds_read_b32 v200, v202 offset:60000
  s_waitcnt lgkmcnt(0)
  v_readfirstlane_b32 s62, v200
  s_add_u32 s56, s46, 20971520
  s_addc_u32 s57, s47, 0
  s_mov_b32 s58, 16384
  s_mov_b32 s59, 0x20000
  v_sub_f32 v10, 0, v7
  v_cvt_pk_bf16_f32 v10, v10, v8
  v_mov_b32 v11, s62
  v_add_u32 v12, s4, v4
  v_lshlrev_b32 v12, 3, v12
  v_cmp_eq_u32 vcc, 0, v5
  s_nop 0
  s_and_saveexec_b64 s[8:9], vcc
  buffer_store_dwordx2 v[10:11], v12, s[56:59], 0 offen sc1
  s_mov_b64 exec, s[8:9]
  v_sub_f32 v146, 0, v7
  v_mov_b32 v148, v9
  v_sub_f32 v150, 0, v8
  v_pk_add_f32 v[64:65], v[64:65], v[146:147] op_sel_hi:[1,0]
  v_pk_add_f32 v[66:67], v[66:67], v[146:147] op_sel_hi:[1,0]
  v_pk_add_f32 v[68:69], v[68:69], v[146:147] op_sel_hi:[1,0]
  v_pk_add_f32 v[70:71], v[70:71], v[146:147] op_sel_hi:[1,0]
  v_cvt_pk_bf16_f32 v152, v64, v65
  v_cvt_pk_bf16_f32 v154, v66, v67
  v_cvt_pk_bf16_f32 v156, v68, v69
  v_cvt_pk_bf16_f32 v158, v70, v71
  v_lshlrev_b32 v64, 16, v152
  v_and_b32 v65, 0xffff0000, v152
  v_lshlrev_b32 v66, 16, v154
  v_and_b32 v67, 0xffff0000, v154
  v_lshlrev_b32 v68, 16, v156
  v_and_b32 v69, 0xffff0000, v156
  v_lshlrev_b32 v70, 16, v158
  v_and_b32 v71, 0xffff0000, v158
  v_pk_mul_f32 v[152:153], v[64:65], v[148:149] op_sel_hi:[1,0]
  v_pk_mul_f32 v[154:155], v[66:67], v[148:149] op_sel_hi:[1,0]
  v_pk_mul_f32 v[156:157], v[68:69], v[148:149] op_sel_hi:[1,0]
  v_pk_mul_f32 v[158:159], v[70:71], v[148:149] op_sel_hi:[1,0]
  v_pk_fma_f32 v[64:65], v[152:153], v[150:151], v[64:65] op_sel_hi:[1,0,1]
  v_pk_fma_f32 v[66:67], v[154:155], v[150:151], v[66:67] op_sel_hi:[1,0,1]
  v_pk_fma_f32 v[68:69], v[156:157], v[150:151], v[68:69] op_sel_hi:[1,0,1]
  v_pk_fma_f32 v[70:71], v[158:159], v[150:151], v[70:71] op_sel_hi:[1,0,1]
  v_pk_fma_f32 v[152:153], v[64:65], v[148:149], v[152:153] op_sel_hi:[1,0,1]
  v_pk_fma_f32 v[154:155], v[66:67], v[148:149], v[154:155] op_sel_hi:[1,0,1]
  v_pk_fma_f32 v[156:157], v[68:69], v[148:149], v[156:157] op_sel_hi:[1,0,1]
  v_pk_fma_f32 v[158:159], v[70:71], v[148:149], v[158:159] op_sel_hi:[1,0,1]
  v_cvt_pk_bf16_f32 v16, v152, v153
  v_cvt_pk_bf16_f32 v17, v154, v155
  v_cvt_pk_bf16_f32 v18, v156, v157
  v_cvt_pk_bf16_f32 v19, v158, v159
  ds_write_b128 v1, v[16:19] offset:0
  v_pk_add_f32 v[72:73], v[72:73], v[146:147] op_sel_hi:[1,0]
  v_pk_add_f32 v[74:75], v[74:75], v[146:147] op_sel_hi:[1,0]
  v_pk_add_f32 v[76:77], v[76:77], v[146:147] op_sel_hi:[1,0]
  v_pk_add_f32 v[78:79], v[78:79], v[146:147] op_sel_hi:[1,0]
  v_cvt_pk_bf16_f32 v152, v72, v73
  v_cvt_pk_bf16_f32 v154, v74, v75
  v_cvt_pk_bf16_f32 v156, v76, v77
  v_cvt_pk_bf16_f32 v158, v78, v79
  v_lshlrev_b32 v72, 16, v152
  v_and_b32 v73, 0xffff0000, v152
  v_lshlrev_b32 v74, 16, v154
  v_and_b32 v75, 0xffff0000, v154
  v_lshlrev_b32 v76, 16, v156
  v_and_b32 v77, 0xffff0000, v156
  v_lshlrev_b32 v78, 16, v158
  v_and_b32 v79, 0xffff0000, v158
  v_pk_mul_f32 v[152:153], v[72:73], v[148:149] op_sel_hi:[1,0]
  v_pk_mul_f32 v[154:155], v[74:75], v[148:149] op_sel_hi:[1,0]
  v_pk_mul_f32 v[156:157], v[76:77], v[148:149] op_sel_hi:[1,0]
  v_pk_mul_f32 v[158:159], v[78:79], v[148:149] op_sel_hi:[1,0]
  v_pk_fma_f32 v[72:73], v[152:153], v[150:151], v[72:73] op_sel_hi:[1,0,1]
  v_pk_fma_f32 v[74:75], v[154:155], v[150:151], v[74:75] op_sel_hi:[1,0,1]
  v_pk_fma_f32 v[76:77], v[156:157], v[150:151], v[76:77] op_sel_hi:[1,0,1]
  v_pk_fma_f32 v[78:79], v[158:159], v[150:151], v[78:79] op_sel_hi:[1,0,1]
  v_pk_fma_f32 v[152:153], v[72:73], v[148:149], v[152:153] op_sel_hi:[1,0,1]
  v_pk_fma_f32 v[154:155], v[74:75], v[148:149], v[154:155] op_sel_hi:[1,0,1]
  v_pk_fma_f32 v[156:157], v[76:77], v[148:149], v[156:157] op_sel_hi:[1,0,1]
  v_pk_fma_f32 v[158:159], v[78:79], v[148:149], v[158:159] op_sel_hi:[1,0,1]
  v_cvt_pk_bf16_f32 v20, v152, v153
  v_cvt_pk_bf16_f32 v21, v154, v155
  v_cvt_pk_bf16_f32 v22, v156, v157
  v_cvt_pk_bf16_f32 v23, v158, v159
  ds_write_b128 v1, v[20:23] offset:128
  v_pk_add_f32 v[80:81], v[80:81], v[146:147] op_sel_hi:[1,0]
  v_pk_add_f32 v[82:83], v[82:83], v[146:147] op_sel_hi:[1,0]
  v_pk_add_f32 v[84:85], v[84:85], v[146:147] op_sel_hi:[1,0]
  v_pk_add_f32 v[86:87], v[86:87], v[146:147] op_sel_hi:[1,0]
  v_cvt_pk_bf16_f32 v152, v80, v81
  v_cvt_pk_bf16_f32 v154, v82, v83
  v_cvt_pk_bf16_f32 v156, v84, v85
  v_cvt_pk_bf16_f32 v158, v86, v87
  v_lshlrev_b32 v80, 16, v152
  v_and_b32 v81, 0xffff0000, v152
  v_lshlrev_b32 v82, 16, v154
  v_and_b32 v83, 0xffff0000, v154
  v_lshlrev_b32 v84, 16, v156
  v_and_b32 v85, 0xffff0000, v156
  v_lshlrev_b32 v86, 16, v158
  v_and_b32 v87, 0xffff0000, v158
  v_pk_mul_f32 v[152:153], v[80:81], v[148:149] op_sel_hi:[1,0]
  v_pk_mul_f32 v[154:155], v[82:83], v[148:149] op_sel_hi:[1,0]
  v_pk_mul_f32 v[156:157], v[84:85], v[148:149] op_sel_hi:[1,0]
  v_pk_mul_f32 v[158:159], v[86:87], v[148:149] op_sel_hi:[1,0]
  v_pk_fma_f32 v[80:81], v[152:153], v[150:151], v[80:81] op_sel_hi:[1,0,1]
  v_pk_fma_f32 v[82:83], v[154:155], v[150:151], v[82:83] op_sel_hi:[1,0,1]
  v_pk_fma_f32 v[84:85], v[156:157], v[150:151], v[84:85] op_sel_hi:[1,0,1]
  v_pk_fma_f32 v[86:87], v[158:159], v[150:151], v[86:87] op_sel_hi:[1,0,1]
  v_pk_fma_f32 v[152:153], v[80:81], v[148:149], v[152:153] op_sel_hi:[1,0,1]
  v_pk_fma_f32 v[154:155], v[82:83], v[148:149], v[154:155] op_sel_hi:[1,0,1]
  v_pk_fma_f32 v[156:157], v[84:85], v[148:149], v[156:157] op_sel_hi:[1,0,1]
  v_pk_fma_f32 v[158:159], v[86:87], v[148:149], v[158:159] op_sel_hi:[1,0,1]
  v_cvt_pk_bf16_f32 v24, v152, v153
  v_cvt_pk_bf16_f32 v25, v154, v155
  v_cvt_pk_bf16_f32 v26, v156, v157
  v_cvt_pk_bf16_f32 v27, v158, v159
  ds_write_b128 v1, v[24:27] offset:256
  v_pk_add_f32 v[88:89], v[88:89], v[146:147] op_sel_hi:[1,0]
  v_pk_add_f32 v[90:91], v[90:91], v[146:147] op_sel_hi:[1,0]
  v_pk_add_f32 v[92:93], v[92:93], v[146:147] op_sel_hi:[1,0]
  v_pk_add_f32 v[94:95], v[94:95], v[146:147] op_sel_hi:[1,0]
  v_cvt_pk_bf16_f32 v152, v88, v89
  v_cvt_pk_bf16_f32 v154, v90, v91
  v_cvt_pk_bf16_f32 v156, v92, v93
  v_cvt_pk_bf16_f32 v158, v94, v95
  v_lshlrev_b32 v88, 16, v152
  v_and_b32 v89, 0xffff0000, v152
  v_lshlrev_b32 v90, 16, v154
  v_and_b32 v91, 0xffff0000, v154
  v_lshlrev_b32 v92, 16, v156
  v_and_b32 v93, 0xffff0000, v156
  v_lshlrev_b32 v94, 16, v158
  v_and_b32 v95, 0xffff0000, v158
  v_pk_mul_f32 v[152:153], v[88:89], v[148:149] op_sel_hi:[1,0]
  v_pk_mul_f32 v[154:155], v[90:91], v[148:149] op_sel_hi:[1,0]
  v_pk_mul_f32 v[156:157], v[92:93], v[148:149] op_sel_hi:[1,0]
  v_pk_mul_f32 v[158:159], v[94:95], v[148:149] op_sel_hi:[1,0]
  v_pk_fma_f32 v[88:89], v[152:153], v[150:151], v[88:89] op_sel_hi:[1,0,1]
  v_pk_fma_f32 v[90:91], v[154:155], v[150:151], v[90:91] op_sel_hi:[1,0,1]
  v_pk_fma_f32 v[92:93], v[156:157], v[150:151], v[92:93] op_sel_hi:[1,0,1]
  v_pk_fma_f32 v[94:95], v[158:159], v[150:151], v[94:95] op_sel_hi:[1,0,1]
  v_pk_fma_f32 v[152:153], v[88:89], v[148:149], v[152:153] op_sel_hi:[1,0,1]
  v_pk_fma_f32 v[154:155], v[90:91], v[148:149], v[154:155] op_sel_hi:[1,0,1]
  v_pk_fma_f32 v[156:157], v[92:93], v[148:149], v[156:157] op_sel_hi:[1,0,1]
  v_pk_fma_f32 v[158:159], v[94:95], v[148:149], v[158:159] op_sel_hi:[1,0,1]
  v_cvt_pk_bf16_f32 v28, v152, v153
  v_cvt_pk_bf16_f32 v29, v154, v155
  v_cvt_pk_bf16_f32 v30, v156, v157
  v_cvt_pk_bf16_f32 v31, v158, v159
  ds_write_b128 v1, v[28:31] offset:384
  v_pk_add_f32 v[96:97], v[96:97], v[146:147] op_sel_hi:[1,0]
  v_pk_add_f32 v[98:99], v[98:99], v[146:147] op_sel_hi:[1,0]
  v_pk_add_f32 v[100:101], v[100:101], v[146:147] op_sel_hi:[1,0]
  v_pk_add_f32 v[102:103], v[102:103], v[146:147] op_sel_hi:[1,0]
  v_cvt_pk_bf16_f32 v152, v96, v97
  v_cvt_pk_bf16_f32 v154, v98, v99
  v_cvt_pk_bf16_f32 v156, v100, v101
  v_cvt_pk_bf16_f32 v158, v102, v103
  v_lshlrev_b32 v96, 16, v152
  v_and_b32 v97, 0xffff0000, v152
  v_lshlrev_b32 v98, 16, v154
  v_and_b32 v99, 0xffff0000, v154
  v_lshlrev_b32 v100, 16, v156
  v_and_b32 v101, 0xffff0000, v156
  v_lshlrev_b32 v102, 16, v158
  v_and_b32 v103, 0xffff0000, v158
  v_pk_mul_f32 v[152:153], v[96:97], v[148:149] op_sel_hi:[1,0]
  v_pk_mul_f32 v[154:155], v[98:99], v[148:149] op_sel_hi:[1,0]
  v_pk_mul_f32 v[156:157], v[100:101], v[148:149] op_sel_hi:[1,0]
  v_pk_mul_f32 v[158:159], v[102:103], v[148:149] op_sel_hi:[1,0]
  v_pk_fma_f32 v[96:97], v[152:153], v[150:151], v[96:97] op_sel_hi:[1,0,1]
  v_pk_fma_f32 v[98:99], v[154:155], v[150:151], v[98:99] op_sel_hi:[1,0,1]
  v_pk_fma_f32 v[100:101], v[156:157], v[150:151], v[100:101] op_sel_hi:[1,0,1]
  v_pk_fma_f32 v[102:103], v[158:159], v[150:151], v[102:103] op_sel_hi:[1,0,1]
  v_pk_fma_f32 v[152:153], v[96:97], v[148:149], v[152:153] op_sel_hi:[1,0,1]
  v_pk_fma_f32 v[154:155], v[98:99], v[148:149], v[154:155] op_sel_hi:[1,0,1]
  v_pk_fma_f32 v[156:157], v[100:101], v[148:149], v[156:157] op_sel_hi:[1,0,1]
  v_pk_fma_f32 v[158:159], v[102:103], v[148:149], v[158:159] op_sel_hi:[1,0,1]
  v_cvt_pk_bf16_f32 v32, v152, v153
  v_cvt_pk_bf16_f32 v33, v154, v155
  v_cvt_pk_bf16_f32 v34, v156, v157
  v_cvt_pk_bf16_f32 v35, v158, v159
  ds_write_b128 v1, v[32:35] offset:512
  v_pk_add_f32 v[104:105], v[104:105], v[146:147] op_sel_hi:[1,0]
  v_pk_add_f32 v[106:107], v[106:107], v[146:147] op_sel_hi:[1,0]
  v_pk_add_f32 v[108:109], v[108:109], v[146:147] op_sel_hi:[1,0]
  v_pk_add_f32 v[110:111], v[110:111], v[146:147] op_sel_hi:[1,0]
  v_cvt_pk_bf16_f32 v152, v104, v105
  v_cvt_pk_bf16_f32 v154, v106, v107
  v_cvt_pk_bf16_f32 v156, v108, v109
  v_cvt_pk_bf16_f32 v158, v110, v111
  v_lshlrev_b32 v104, 16, v152
  v_and_b32 v105, 0xffff0000, v152
  v_lshlrev_b32 v106, 16, v154
  v_and_b32 v107, 0xffff0000, v154
  v_lshlrev_b32 v108, 16, v156
  v_and_b32 v109, 0xffff0000, v156
  v_lshlrev_b32 v110, 16, v158
  v_and_b32 v111, 0xffff0000, v158
  v_pk_mul_f32 v[152:153], v[104:105], v[148:149] op_sel_hi:[1,0]
  v_pk_mul_f32 v[154:155], v[106:107], v[148:149] op_sel_hi:[1,0]
  v_pk_mul_f32 v[156:157], v[108:109], v[148:149] op_sel_hi:[1,0]
  v_pk_mul_f32 v[158:159], v[110:111], v[148:149] op_sel_hi:[1,0]
  v_pk_fma_f32 v[104:105], v[152:153], v[150:151], v[104:105] op_sel_hi:[1,0,1]
  v_pk_fma_f32 v[106:107], v[154:155], v[150:151], v[106:107] op_sel_hi:[1,0,1]
  v_pk_fma_f32 v[108:109], v[156:157], v[150:151], v[108:109] op_sel_hi:[1,0,1]
  v_pk_fma_f32 v[110:111], v[158:159], v[150:151], v[110:111] op_sel_hi:[1,0,1]
  v_pk_fma_f32 v[152:153], v[104:105], v[148:149], v[152:153] op_sel_hi:[1,0,1]
  v_pk_fma_f32 v[154:155], v[106:107], v[148:149], v[154:155] op_sel_hi:[1,0,1]
  v_pk_fma_f32 v[156:157], v[108:109], v[148:149], v[156:157] op_sel_hi:[1,0,1]
  v_pk_fma_f32 v[158:159], v[110:111], v[148:149], v[158:159] op_sel_hi:[1,0,1]
  v_cvt_pk_bf16_f32 v36, v152, v153
  v_cvt_pk_bf16_f32 v37, v154, v155
  v_cvt_pk_bf16_f32 v38, v156, v157
  v_cvt_pk_bf16_f32 v39, v158, v159
  ds_write_b128 v1, v[36:39] offset:640
  v_pk_add_f32 v[112:113], v[112:113], v[146:147] op_sel_hi:[1,0]
  v_pk_add_f32 v[114:115], v[114:115], v[146:147] op_sel_hi:[1,0]
  v_pk_add_f32 v[116:117], v[116:117], v[146:147] op_sel_hi:[1,0]
  v_pk_add_f32 v[118:119], v[118:119], v[146:147] op_sel_hi:[1,0]
  v_cvt_pk_bf16_f32 v152, v112, v113
  v_cvt_pk_bf16_f32 v154, v114, v115
  v_cvt_pk_bf16_f32 v156, v116, v117
  v_cvt_pk_bf16_f32 v158, v118, v119
  v_lshlrev_b32 v112, 16, v152
  v_and_b32 v113, 0xffff0000, v152
  v_lshlrev_b32 v114, 16, v154
  v_and_b32 v115, 0xffff0000, v154
  v_lshlrev_b32 v116, 16, v156
  v_and_b32 v117, 0xffff0000, v156
  v_lshlrev_b32 v118, 16, v158
  v_and_b32 v119, 0xffff0000, v158
  v_pk_mul_f32 v[152:153], v[112:113], v[148:149] op_sel_hi:[1,0]
  v_pk_mul_f32 v[154:155], v[114:115], v[148:149] op_sel_hi:[1,0]
  v_pk_mul_f32 v[156:157], v[116:117], v[148:149] op_sel_hi:[1,0]
  v_pk_mul_f32 v[158:159], v[118:119], v[148:149] op_sel_hi:[1,0]
  v_pk_fma_f32 v[112:113], v[152:153], v[150:151], v[112:113] op_sel_hi:[1,0,1]
  v_pk_fma_f32 v[114:115], v[154:155], v[150:151], v[114:115] op_sel_hi:[1,0,1]
  v_pk_fma_f32 v[116:117], v[156:157], v[150:151], v[116:117] op_sel_hi:[1,0,1]
  v_pk_fma_f32 v[118:119], v[158:159], v[150:151], v[118:119] op_sel_hi:[1,0,1]
  v_pk_fma_f32 v[152:153], v[112:113], v[148:149], v[152:153] op_sel_hi:[1,0,1]
  v_pk_fma_f32 v[154:155], v[114:115], v[148:149], v[154:155] op_sel_hi:[1,0,1]
  v_pk_fma_f32 v[156:157], v[116:117], v[148:149], v[156:157] op_sel_hi:[1,0,1]
  v_pk_fma_f32 v[158:159], v[118:119], v[148:149], v[158:159] op_sel_hi:[1,0,1]
  v_cvt_pk_bf16_f32 v40, v152, v153
  v_cvt_pk_bf16_f32 v41, v154, v155
  v_cvt_pk_bf16_f32 v42, v156, v157
  v_cvt_pk_bf16_f32 v43, v158, v159
  ds_write_b128 v1, v[40:43] offset:768
  v_pk_add_f32 v[120:121], v[120:121], v[146:147] op_sel_hi:[1,0]
  v_pk_add_f32 v[122:123], v[122:123], v[146:147] op_sel_hi:[1,0]
  v_pk_add_f32 v[124:125], v[124:125], v[146:147] op_sel_hi:[1,0]
  v_pk_add_f32 v[126:127], v[126:127], v[146:147] op_sel_hi:[1,0]
  v_cvt_pk_bf16_f32 v152, v120, v121
  v_cvt_pk_bf16_f32 v154, v122, v123
  v_cvt_pk_bf16_f32 v156, v124, v125
  v_cvt_pk_bf16_f32 v158, v126, v127
  v_lshlrev_b32 v120, 16, v152
  v_and_b32 v121, 0xffff0000, v152
  v_lshlrev_b32 v122, 16, v154
  v_and_b32 v123, 0xffff0000, v154
  v_lshlrev_b32 v124, 16, v156
  v_and_b32 v125, 0xffff0000, v156
  v_lshlrev_b32 v126, 16, v158
  v_and_b32 v127, 0xffff0000, v158
  v_pk_mul_f32 v[152:153], v[120:121], v[148:149] op_sel_hi:[1,0]
  v_pk_mul_f32 v[154:155], v[122:123], v[148:149] op_sel_hi:[1,0]
  v_pk_mul_f32 v[156:157], v[124:125], v[148:149] op_sel_hi:[1,0]
  v_pk_mul_f32 v[158:159], v[126:127], v[148:149] op_sel_hi:[1,0]
  v_pk_fma_f32 v[120:121], v[152:153], v[150:151], v[120:121] op_sel_hi:[1,0,1]
  v_pk_fma_f32 v[122:123], v[154:155], v[150:151], v[122:123] op_sel_hi:[1,0,1]
  v_pk_fma_f32 v[124:125], v[156:157], v[150:151], v[124:125] op_sel_hi:[1,0,1]
  v_pk_fma_f32 v[126:127], v[158:159], v[150:151], v[126:127] op_sel_hi:[1,0,1]
  v_pk_fma_f32 v[152:153], v[120:121], v[148:149], v[152:153] op_sel_hi:[1,0,1]
  v_pk_fma_f32 v[154:155], v[122:123], v[148:149], v[154:155] op_sel_hi:[1,0,1]
  v_pk_fma_f32 v[156:157], v[124:125], v[148:149], v[156:157] op_sel_hi:[1,0,1]
  v_pk_fma_f32 v[158:159], v[126:127], v[148:149], v[158:159] op_sel_hi:[1,0,1]
  v_cvt_pk_bf16_f32 v44, v152, v153
  v_cvt_pk_bf16_f32 v45, v154, v155
  v_cvt_pk_bf16_f32 v46, v156, v157
  v_cvt_pk_bf16_f32 v47, v158, v159
  ds_write_b128 v1, v[44:47] offset:896
  v_pk_add_f32 v[128:129], v[128:129], v[146:147] op_sel_hi:[1,0]
  v_pk_add_f32 v[130:131], v[130:131], v[146:147] op_sel_hi:[1,0]
  v_pk_add_f32 v[132:133], v[132:133], v[146:147] op_sel_hi:[1,0]
  v_pk_add_f32 v[134:135], v[134:135], v[146:147] op_sel_hi:[1,0]
  v_cvt_pk_bf16_f32 v152, v128, v129
  v_cvt_pk_bf16_f32 v154, v130, v131
  v_cvt_pk_bf16_f32 v156, v132, v133
  v_cvt_pk_bf16_f32 v158, v134, v135
  v_lshlrev_b32 v128, 16, v152
  v_and_b32 v129, 0xffff0000, v152
  v_lshlrev_b32 v130, 16, v154
  v_and_b32 v131, 0xffff0000, v154
  v_lshlrev_b32 v132, 16, v156
  v_and_b32 v133, 0xffff0000, v156
  v_lshlrev_b32 v134, 16, v158
  v_and_b32 v135, 0xffff0000, v158
  v_pk_mul_f32 v[152:153], v[128:129], v[148:149] op_sel_hi:[1,0]
  v_pk_mul_f32 v[154:155], v[130:131], v[148:149] op_sel_hi:[1,0]
  v_pk_mul_f32 v[156:157], v[132:133], v[148:149] op_sel_hi:[1,0]
  v_pk_mul_f32 v[158:159], v[134:135], v[148:149] op_sel_hi:[1,0]
  v_pk_fma_f32 v[128:129], v[152:153], v[150:151], v[128:129] op_sel_hi:[1,0,1]
  v_pk_fma_f32 v[130:131], v[154:155], v[150:151], v[130:131] op_sel_hi:[1,0,1]
  v_pk_fma_f32 v[132:133], v[156:157], v[150:151], v[132:133] op_sel_hi:[1,0,1]
  v_pk_fma_f32 v[134:135], v[158:159], v[150:151], v[134:135] op_sel_hi:[1,0,1]
  v_pk_fma_f32 v[152:153], v[128:129], v[148:149], v[152:153] op_sel_hi:[1,0,1]
  v_pk_fma_f32 v[154:155], v[130:131], v[148:149], v[154:155] op_sel_hi:[1,0,1]
  v_pk_fma_f32 v[156:157], v[132:133], v[148:149], v[156:157] op_sel_hi:[1,0,1]
  v_pk_fma_f32 v[158:159], v[134:135], v[148:149], v[158:159] op_sel_hi:[1,0,1]
  v_cvt_pk_bf16_f32 v48, v152, v153
  v_cvt_pk_bf16_f32 v49, v154, v155
  v_cvt_pk_bf16_f32 v50, v156, v157
  v_cvt_pk_bf16_f32 v51, v158, v159
  ds_write_b128 v1, v[48:51] offset:1024
  v_pk_add_f32 v[136:137], v[136:137], v[146:147] op_sel_hi:[1,0]
  v_pk_add_f32 v[138:139], v[138:139], v[146:147] op_sel_hi:[1,0]
  v_pk_add_f32 v[140:141], v[140:141], v[146:147] op_sel_hi:[1,0]
  v_pk_add_f32 v[142:143], v[142:143], v[146:147] op_sel_hi:[1,0]
  v_cvt_pk_bf16_f32 v152, v136, v137
  v_cvt_pk_bf16_f32 v154, v138, v139
  v_cvt_pk_bf16_f32 v156, v140, v141
  v_cvt_pk_bf16_f32 v158, v142, v143
  v_lshlrev_b32 v136, 16, v152
  v_and_b32 v137, 0xffff0000, v152
  v_lshlrev_b32 v138, 16, v154
  v_and_b32 v139, 0xffff0000, v154
  v_lshlrev_b32 v140, 16, v156
  v_and_b32 v141, 0xffff0000, v156
  v_lshlrev_b32 v142, 16, v158
  v_and_b32 v143, 0xffff0000, v158
  v_pk_mul_f32 v[152:153], v[136:137], v[148:149] op_sel_hi:[1,0]
  v_pk_mul_f32 v[154:155], v[138:139], v[148:149] op_sel_hi:[1,0]
  v_pk_mul_f32 v[156:157], v[140:141], v[148:149] op_sel_hi:[1,0]
  v_pk_mul_f32 v[158:159], v[142:143], v[148:149] op_sel_hi:[1,0]
  v_pk_fma_f32 v[136:137], v[152:153], v[150:151], v[136:137] op_sel_hi:[1,0,1]
  v_pk_fma_f32 v[138:139], v[154:155], v[150:151], v[138:139] op_sel_hi:[1,0,1]
  v_pk_fma_f32 v[140:141], v[156:157], v[150:151], v[140:141] op_sel_hi:[1,0,1]
  v_pk_fma_f32 v[142:143], v[158:159], v[150:151], v[142:143] op_sel_hi:[1,0,1]
  v_pk_fma_f32 v[152:153], v[136:137], v[148:149], v[152:153] op_sel_hi:[1,0,1]
  v_pk_fma_f32 v[154:155], v[138:139], v[148:149], v[154:155] op_sel_hi:[1,0,1]
  v_pk_fma_f32 v[156:157], v[140:141], v[148:149], v[156:157] op_sel_hi:[1,0,1]
  v_pk_fma_f32 v[158:159], v[142:143], v[148:149], v[158:159] op_sel_hi:[1,0,1]
  v_cvt_pk_bf16_f32 v52, v152, v153
  v_cvt_pk_bf16_f32 v53, v154, v155
  v_cvt_pk_bf16_f32 v54, v156, v157
  v_cvt_pk_bf16_f32 v55, v158, v159
  ds_write_b128 v1, v[52:55] offset:1152
  s_waitcnt lgkmcnt(0)
  s_barrier
  v_lshrrev_b32 v4, 4, v2
  v_bfe_u32 v5, v2, 2, 2
  v_lshlrev_b32 v5, 2, v5
  v_add_u32 v5, v5, v4
  v_mul_u32_u24 v5, 1296, v5
  v_and_b32 v6, 3, v2
  v_lshlrev_b32 v6, 3, v6
  v_add_u32 v5, v5, v6
  v_lshlrev_b32 v6, 5, v3
  v_add_u32 v5, v5, v6
  v_and_b32 v6, 15, v2
  v_lshlrev_b32 v7, 4, v3
  v_add_u32 v6, v6, v7
  v_lshlrev_b32 v6, 6, v6
  v_lshlrev_b32 v7, 4, v4
  v_add_u32 v6, v6, v7
  s_mul_i32 s4, s3, 40960
  ds_read_b64_tr_b16 v[16:17], v5 offset:0
  ds_read_b64_tr_b16 v[18:19], v5 offset:20736
  ds_read_b64_tr_b16 v[20:21], v5 offset:128
  ds_read_b64_tr_b16 v[22:23], v5 offset:20864
  ds_read_b64_tr_b16 v[24:25], v5 offset:256
  ds_read_b64_tr_b16 v[26:27], v5 offset:20992
  ds_read_b64_tr_b16 v[28:29], v5 offset:384
  ds_read_b64_tr_b16 v[30:31], v5 offset:21120
  ds_read_b64_tr_b16 v[32:33], v5 offset:512
  ds_read_b64_tr_b16 v[34:35], v5 offset:21248
  ds_read_b64_tr_b16 v[36:37], v5 offset:640
  ds_read_b64_tr_b16 v[38:39], v5 offset:21376
  ds_read_b64_tr_b16 v[40:41], v5 offset:768
  ds_read_b64_tr_b16 v[42:43], v5 offset:21504
  ds_read_b64_tr_b16 v[44:45], v5 offset:896
  ds_read_b64_tr_b16 v[46:47], v5 offset:21632
  ds_read_b64_tr_b16 v[48:49], v5 offset:1024
  ds_read_b64_tr_b16 v[50:51], v5 offset:21760
  ds_read_b64_tr_b16 v[52:53], v5 offset:1152
  ds_read_b64_tr_b16 v[54:55], v5 offset:21888
  s_waitcnt lgkmcnt(15)
  buffer_store_dwordx4 v[16:19], v6, s[52:55], s4 offen sc1
  s_add_u32 s4, s4, 4096
  s_waitcnt lgkmcnt(15)
  buffer_store_dwordx4 v[20:23], v6, s[52:55], s4 offen sc1
  s_add_u32 s4, s4, 4096
  s_waitcnt lgkmcnt(14)
  buffer_store_dwordx4 v[24:27], v6, s[52:55], s4 offen sc1
  s_add_u32 s4, s4, 4096
  s_waitcnt lgkmcnt(12)
  buffer_store_dwordx4 v[28:31], v6, s[52:55], s4 offen sc1
  s_add_u32 s4, s4, 4096
  s_waitcnt lgkmcnt(10)
  buffer_store_dwordx4 v[32:35], v6, s[52:55], s4 offen sc1
  s_add_u32 s4, s4, 4096
  s_waitcnt lgkmcnt(8)
  buffer_store_dwordx4 v[36:39], v6, s[52:55], s4 offen sc1
  s_add_u32 s4, s4, 4096
  s_waitcnt lgkmcnt(6)
  buffer_store_dwordx4 v[40:43], v6, s[52:55], s4 offen sc1
  s_add_u32 s4, s4, 4096
  s_waitcnt lgkmcnt(4)
  buffer_store_dwordx4 v[44:47], v6, s[52:55], s4 offen sc1
  s_add_u32 s4, s4, 4096
  s_waitcnt lgkmcnt(2)
  buffer_store_dwordx4 v[48:51], v6, s[52:55], s4 offen sc1
  s_add_u32 s4, s4, 4096
  s_waitcnt lgkmcnt(0)
  buffer_store_dwordx4 v[52:55], v6, s[52:55], s4 offen sc1
  s_endpgm
l1_kernel_r2:
  s_sub_u32 s3, s2, 256
  s_waitcnt lgkmcnt(0)
  s_lshr_b32 s4, s3, 3
  s_lshl_b32 s4, s4, 2
  s_and_b32 s5, s3, 3
  s_add_u32 s4, s4, s5
  s_bfe_u32 s5, s3, 0x10002
  s_mul_i32 s5, s5, 14
  s_add_u32 s3, s4, s5
  s_cmp_lt_u32 s4, 14
  s_cselect_b32 s4, 1, 0
  s_cmp_lt_u32 s3, 27
  s_cselect_b32 s4, s4, 0
  s_cmp_lg_u32 s4, 0
  s_cbranch_scc1 cs_go_8
  s_endpgm
cs_go_8:
  s_mov_b32 s48, s36
  s_mov_b32 s49, s37
  s_mov_b32 s50, 2211840
  s_mov_b32 s51, 0x20000
  s_add_u32 s52, s46, 21037056
  s_addc_u32 s53, s47, 0
  s_mov_b32 s54, 14336
  s_mov_b32 s55, 0x20000
  v_lshrrev_b32 v4, 3, v0
  v_and_b32 v5, 7, v0
  v_mul_u32_u24 v6, 3456, v4
  v_lshl_add_u32 v6, v5, 4, v6
  s_lshl_b32 s4, s3, 7
  buffer_load_dwordx4 v[16:19], v6, s[48:51], s4 offen
  s_add_u32 s4, s4, 110592
  buffer_load_dwordx4 v[20:23], v6, s[48:51], s4 offen
  s_add_u32 s4, s4, 110592
  buffer_load_dwordx4 v[24:27], v6, s[48:51], s4 offen
  s_add_u32 s4, s4, 110592
  buffer_load_dwordx4 v[28:31], v6, s[48:51], s4 offen
  s_add_u32 s4, s4, 110592
  buffer_load_dwordx4 v[32:35], v6, s[48:51], s4 offen
  s_add_u32 s4, s4, 110592
  buffer_load_dwordx4 v[36:39], v6, s[48:51], s4 offen
  s_add_u32 s4, s4, 110592
  buffer_load_dwordx4 v[40:43], v6, s[48:51], s4 offen
  s_add_u32 s4, s4, 110592
  buffer_load_dwordx4 v[44:47], v6, s[48:51], s4 offen
  s_add_u32 s4, s4, 110592
  buffer_load_dwordx4 v[48:51], v6, s[48:51], s4 offen
  s_add_u32 s4, s4, 110592
  buffer_load_dwordx4 v[52:55], v6, s[48:51], s4 offen
  s_add_u32 s4, s4, 110592
  buffer_load_dwordx4 v[56:59], v6, s[48:51], s4 offen
  s_add_u32 s4, s4, 110592
  buffer_load_dwordx4 v[60:63], v6, s[48:51], s4 offen
  s_add_u32 s4, s4, 110592
  buffer_load_dwordx4 v[64:67], v6, s[48:51], s4 offen
  s_add_u32 s4, s4, 110592
  buffer_load_dwordx4 v[68:71], v6, s[48:51], s4 offen
  s_add_u32 s4, s4, 110592
  buffer_load_dwordx4 v[72:75], v6, s[48:51], s4 offen
  s_add_u32 s4, s4, 110592
  buffer_load_dwordx4 v[76:79], v6, s[48:51], s4 offen
  s_add_u32 s4, s4, 110592
  buffer_load_dwordx4 v[80:83], v6, s[48:51], s4 offen
  s_add_u32 s4, s4, 110592
  buffer_load_dwordx4 v[84:87], v6, s[48:51], s4 offen
  s_add_u32 s4, s4, 110592
  buffer_load_dwordx4 v[88:91], v6, s[48:51], s4 offen
  s_add_u32 s4, s4, 110592
  buffer_load_dwordx4 v[92:95], v6, s[48:51], s4 offen
  s_mov_b32 s12, s44
  s_mov_b32 s13, s45
  s_mov_b32 s14, 256
  s_mov_b32 s15, 0x20000
  s_memrealtime s[62:63]
  s_waitcnt lgkmcnt(0)
  s_or_b32 s62, s62, 1
  v_mov_b32 v200, s62
  v_mov_b32 v201, 0
  v_mov_b32 v202, 0
  v_cmp_eq_u32 vcc, 0, v0
  s_nop 0
  s_and_saveexec_b64 s[8:9], vcc
  s_cbranch_execz nn_9
  buffer_atomic_cmpswap v[200:201], v202, s[12:15], 0 offen sc0 sc1
nn_9:
  s_mov_b64 exec, s[8:9]
  v_mov_b32 v8, 0
  v_mov_b32 v9, 0
  v_mov_b32 v10, 0
  v_mov_b32 v11, 0
  v_mov_b32 v12, 0
  v_mov_b32 v13, 0
  v_mov_b32 v14, 0
  v_mov_b32 v15, 0
  s_waitcnt vmcnt(19)
  v_lshlrev_b32 v100, 16, v16
  v_and_b32 v101, 0xffff0000, v16
  v_pk_add_f32 v[8:9], v[8:9], v[100:101]
  v_lshlrev_b32 v100, 16, v17
  v_and_b32 v101, 0xffff0000, v17
  v_pk_add_f32 v[10:11], v[10:11], v[100:101]
  v_lshlrev_b32 v100, 16, v18
  v_and_b32 v101, 0xffff0000, v18
  v_pk_add_f32 v[12:13], v[12:13], v[100:101]
  v_lshlrev_b32 v100, 16, v19
  v_and_b32 v101, 0xffff0000, v19
  v_pk_add_f32 v[14:15], v[14:15], v[100:101]
  s_waitcnt vmcnt(18)
  v_lshlrev_b32 v100, 16, v20
  v_and_b32 v101, 0xffff0000, v20
  v_pk_add_f32 v[8:9], v[8:9], v[100:101]
  v_lshlrev_b32 v100, 16, v21
  v_and_b32 v101, 0xffff0000, v21
  v_pk_add_f32 v[10:11], v[10:11], v[100:101]
  v_lshlrev_b32 v100, 16, v22
  v_and_b32 v101, 0xffff0000, v22
  v_pk_add_f32 v[12:13], v[12:13], v[100:101]
  v_lshlrev_b32 v100, 16, v23
  v_and_b32 v101, 0xffff0000, v23
  v_pk_add_f32 v[14:15], v[14:15], v[100:101]
  s_waitcnt vmcnt(17)
  v_lshlrev_b32 v100, 16, v24
  v_and_b32 v101, 0xffff0000, v24
  v_pk_add_f32 v[8:9], v[8:9], v[100:101]
  v_lshlrev_b32 v100, 16, v25
  v_and_b32 v101, 0xffff0000, v25
  v_pk_add_f32 v[10:11], v[10:11], v[100:101]
  v_lshlrev_b32 v100, 16, v26
  v_and_b32 v101, 0xffff0000, v26
  v_pk_add_f32 v[12:13], v[12:13], v[100:101]
  v_lshlrev_b32 v100, 16, v27
  v_and_b32 v101, 0xffff0000, v27
  v_pk_add_f32 v[14:15], v[14:15], v[100:101]
  s_waitcnt vmcnt(16)
  v_lshlrev_b32 v100, 16, v28
  v_and_b32 v101, 0xffff0000, v28
  v_pk_add_f32 v[8:9], v[8:9], v[100:101]
  v_lshlrev_b32 v100, 16, v29
  v_and_b32 v101, 0xffff0000, v29
  v_pk_add_f32 v[10:11], v[10:11], v[100:101]
  v_lshlrev_b32 v100, 16, v30
  v_and_b32 v101, 0xffff0000, v30
  v_pk_add_f32 v[12:13], v[12:13], v[100:101]
  v_lshlrev_b32 v100, 16, v31
  v_and_b32 v101, 0xffff0000, v31
  v_pk_add_f32 v[14:15], v[14:15], v[100:101]
  s_waitcnt vmcnt(15)
  v_lshlrev_b32 v100, 16, v32
  v_and_b32 v101, 0xffff0000, v32
  v_pk_add_f32 v[8:9], v[8:9], v[100:101]
  v_lshlrev_b32 v100, 16, v33
  v_and_b32 v101, 0xffff0000, v33
  v_pk_add_f32 v[10:11], v[10:11], v[100:101]
  v_lshlrev_b32 v100, 16, v34
  v_and_b32 v101, 0xffff0000, v34
  v_pk_add_f32 v[12:13], v[12:13], v[100:101]
  v_lshlrev_b32 v100, 16, v35
  v_and_b32 v101, 0xffff0000, v35
  v_pk_add_f32 v[14:15], v[14:15], v[100:101]
  s_waitcnt vmcnt(14)
  v_lshlrev_b32 v100, 16, v36
  v_and_b32 v101, 0xffff0000, v36
  v_pk_add_f32 v[8:9], v[8:9], v[100:101]
  v_lshlrev_b32 v100, 16, v37
  v_and_b32 v101, 0xffff0000, v37
  v_pk_add_f32 v[10:11], v[10:11], v[100:101]
  v_lshlrev_b32 v100, 16, v38
  v_and_b32 v101, 0xffff0000, v38
  v_pk_add_f32 v[12:13], v[12:13], v[100:101]
  v_lshlrev_b32 v100, 16, v39
  v_and_b32 v101, 0xffff0000, v39
  v_pk_add_f32 v[14:15], v[14:15], v[100:101]
  s_waitcnt vmcnt(13)
  v_lshlrev_b32 v100, 16, v40
  v_and_b32 v101, 0xffff0000, v40
  v_pk_add_f32 v[8:9], v[8:9], v[100:101]
  v_lshlrev_b32 v100, 16, v41
  v_and_b32 v101, 0xffff0000, v41
  v_pk_add_f32 v[10:11], v[10:11], v[100:101]
  v_lshlrev_b32 v100, 16, v42
  v_and_b32 v101, 0xffff0000, v42
  v_pk_add_f32 v[12:13], v[12:13], v[100:101]
  v_lshlrev_b32 v100, 16, v43
  v_and_b32 v101, 0xffff0000, v43
  v_pk_add_f32 v[14:15], v[14:15], v[100:101]
  s_waitcnt vmcnt(12)
  v_lshlrev_b32 v100, 16, v44
  v_and_b32 v101, 0xffff0000, v44
  v_pk_add_f32 v[8:9], v[8:9], v[100:101]
  v_lshlrev_b32 v100, 16, v45
  v_and_b32 v101, 0xffff0000, v45
  v_pk_add_f32 v[10:11], v[10:11], v[100:101]
  v_lshlrev_b32 v100, 16, v46
  v_and_b32 v101, 0xffff0000, v46
  v_pk_add_f32 v[12:13], v[12:13], v[100:101]
  v_lshlrev_b32 v100, 16, v47
  v_and_b32 v101, 0xffff0000, v47
  v_pk_add_f32 v[14:15], v[14:15], v[100:101]
  s_waitcnt vmcnt(11)
  v_lshlrev_b32 v100, 16, v48
  v_and_b32 v101, 0xffff0000, v48
  v_pk_add_f32 v[8:9], v[8:9], v[100:101]
  v_lshlrev_b32 v100, 16, v49
  v_and_b32 v101, 0xffff0000, v49
  v_pk_add_f32 v[10:11], v[10:11], v[100:101]
  v_lshlrev_b32 v100, 16, v50
  v_and_b32 v101, 0xffff0000, v50
  v_pk_add_f32 v[12:13], v[12:13], v[100:101]
  v_lshlrev_b32 v100, 16, v51
  v_and_b32 v101, 0xffff0000, v51
  v_pk_add_f32 v[14:15], v[14:15], v[100:101]
  s_waitcnt vmcnt(10)
  v_lshlrev_b32 v100, 16, v52
  v_and_b32 v101, 0xffff0000, v52
  v_pk_add_f32 v[8:9], v[8:9], v[100:101]
  v_lshlrev_b32 v100, 16, v53
  v_and_b32 v101, 0xffff0000, v53
  v_pk_add_f32 v[10:11], v[10:11], v[100:101]
  v_lshlrev_b32 v100, 16, v54
  v_and_b32 v101, 0xffff0000, v54
  v_pk_add_f32 v[12:13], v[12:13], v[100:101]
  v_lshlrev_b32 v100, 16, v55
  v_and_b32 v101, 0xffff0000, v55
  v_pk_add_f32 v[14:15], v[14:15], v[100:101]
  s_waitcnt vmcnt(9)
  v_lshlrev_b32 v100, 16, v56
  v_and_b32 v101, 0xffff0000, v56
  v_pk_add_f32 v[8:9], v[8:9], v[100:101]
  v_lshlrev_b32 v100, 16, v57
  v_and_b32 v101, 0xffff0000, v57
  v_pk_add_f32 v[10:11], v[10:11], v[100:101]
  v_lshlrev_b32 v100, 16, v58
  v_and_b32 v101, 0xffff0000, v58
  v_pk_add_f32 v[12:13], v[12:13], v[100:101]
  v_lshlrev_b32 v100, 16, v59
  v_and_b32 v101, 0xffff0000, v59
  v_pk_add_f32 v[14:15], v[14:15], v[100:101]
  s_waitcnt vmcnt(8)
  v_lshlrev_b32 v100, 16, v60
  v_and_b32 v101, 0xffff0000, v60
  v_pk_add_f32 v[8:9], v[8:9], v[100:101]
  v_lshlrev_b32 v100, 16, v61
  v_and_b32 v101, 0xffff0000, v61
  v_pk_add_f32 v[10:11], v[10:11], v[100:101]
  v_lshlrev_b32 v100, 16, v62
  v_and_b32 v101, 0xffff0000, v62
  v_pk_add_f32 v[12:13], v[12:13], v[100:101]
  v_lshlrev_b32 v100, 16, v63
  v_and_b32 v101, 0xffff0000, v63
  v_pk_add_f32 v[14:15], v[14:15], v[100:101]
  s_waitcnt vmcnt(7)
  v_lshlrev_b32 v100, 16, v64
  v_and_b32 v101, 0xffff0000, v64
  v_pk_add_f32 v[8:9], v[8:9], v[100:101]
  v_lshlrev_b32 v100, 16, v65
  v_and_b32 v101, 0xffff0000, v65
  v_pk_add_f32 v[10:11], v[10:11], v[100:101]
  v_lshlrev_b32 v100, 16, v66
  v_and_b32 v101, 0xffff0000, v66
  v_pk_add_f32 v[12:13], v[12:13], v[100:101]
  v_lshlrev_b32 v100, 16, v67
  v_and_b32 v101, 0xffff0000, v67
  v_pk_add_f32 v[14:15], v[14:15], v[100:101]
  s_waitcnt vmcnt(6)
  v_lshlrev_b32 v100, 16, v68
  v_and_b32 v101, 0xffff0000, v68
  v_pk_add_f32 v[8:9], v[8:9], v[100:101]
  v_lshlrev_b32 v100, 16, v69
  v_and_b32 v101, 0xffff0000, v69
  v_pk_add_f32 v[10:11], v[10:11], v[100:101]
  v_lshlrev_b32 v100, 16, v70
  v_and_b32 v101, 0xffff0000, v70
  v_pk_add_f32 v[12:13], v[12:13], v[100:101]
  v_lshlrev_b32 v100, 16, v71
  v_and_b32 v101, 0xffff0000, v71
  v_pk_add_f32 v[14:15], v[14:15], v[100:101]
  s_waitcnt vmcnt(5)
  v_lshlrev_b32 v100, 16, v72
  v_and_b32 v101, 0xffff0000, v72
  v_pk_add_f32 v[8:9], v[8:9], v[100:101]
  v_lshlrev_b32 v100, 16, v73
  v_and_b32 v101, 0xffff0000, v73
  v_pk_add_f32 v[10:11], v[10:11], v[100:101]
  v_lshlrev_b32 v100, 16, v74
  v_and_b32 v101, 0xffff0000, v74
  v_pk_add_f32 v[12:13], v[12:13], v[100:101]
  v_lshlrev_b32 v100, 16, v75
  v_and_b32 v101, 0xffff0000, v75
  v_pk_add_f32 v[14:15], v[14:15], v[100:101]
  s_waitcnt vmcnt(4)
  v_lshlrev_b32 v100, 16, v76
  v_and_b32 v101, 0xffff0000, v76
  v_pk_add_f32 v[8:9], v[8:9], v[100:101]
  v_lshlrev_b32 v100, 16, v77
  v_and_b32 v101, 0xffff0000, v77
  v_pk_add_f32 v[10:11], v[10:11], v[100:101]
  v_lshlrev_b32 v100, 16, v78
  v_and_b32 v101, 0xffff0000, v78
  v_pk_add_f32 v[12:13], v[12:13], v[100:101]
  v_lshlrev_b32 v100, 16, v79
  v_and_b32 v101, 0xffff0000, v79
  v_pk_add_f32 v[14:15], v[14:15], v[100:101]
  s_waitcnt vmcnt(3)
  v_lshlrev_b32 v100, 16, v80
  v_and_b32 v101, 0xffff0000, v80
  v_pk_add_f32 v[8:9], v[8:9], v[100:101]
  v_lshlrev_b32 v100, 16, v81
  v_and_b32 v101, 0xffff0000, v81
  v_pk_add_f32 v[10:11], v[10:11], v[100:101]
  v_lshlrev_b32 v100, 16, v82
  v_and_b32 v101, 0xffff0000, v82
  v_pk_add_f32 v[12:13], v[12:13], v[100:101]
  v_lshlrev_b32 v100, 16, v83
  v_and_b32 v101, 0xffff0000, v83
  v_pk_add_f32 v[14:15], v[14:15], v[100:101]
  s_waitcnt vmcnt(2)
  v_lshlrev_b32 v100, 16, v84
  v_and_b32 v101, 0xffff0000, v84
  v_pk_add_f32 v[8:9], v[8:9], v[100:101]
  v_lshlrev_b32 v100, 16, v85
  v_and_b32 v101, 0xffff0000, v85
  v_pk_add_f32 v[10:11], v[10:11], v[100:101]
  v_lshlrev_b32 v100, 16, v86
  v_and_b32 v101, 0xffff0000, v86
  v_pk_add_f32 v[12:13], v[12:13], v[100:101]
  v_lshlrev_b32 v100, 16, v87
  v_and_b32 v101, 0xffff0000, v87
  v_pk_add_f32 v[14:15], v[14:15], v[100:101]
  s_waitcnt vmcnt(1)
  v_lshlrev_b32 v100, 16, v88
  v_and_b32 v101, 0xffff0000, v88
  v_pk_add_f32 v[8:9], v[8:9], v[100:101]
  v_lshlrev_b32 v100, 16, v89
  v_and_b32 v101, 0xffff0000, v89
  v_pk_add_f32 v[10:11], v[10:11], v[100:101]
  v_lshlrev_b32 v100, 16, v90
  v_and_b32 v101, 0xffff0000, v90
  v_pk_add_f32 v[12:13], v[12:13], v[100:101]
  v_lshlrev_b32 v100, 16, v91
  v_and_b32 v101, 0xffff0000, v91
  v_pk_add_f32 v[14:15], v[14:15], v[100:101]
  s_waitcnt vmcnt(0)
  v_lshlrev_b32 v100, 16, v92
  v_and_b32 v101, 0xffff0000, v92
  v_pk_add_f32 v[8:9], v[8:9], v[100:101]
  v_lshlrev_b32 v100, 16, v93
  v_and_b32 v101, 0xffff0000, v93
  v_pk_add_f32 v[10:11], v[10:11], v[100:101]
  v_lshlrev_b32 v100, 16, v94
  v_and_b32 v101, 0xffff0000, v94
  v_pk_add_f32 v[12:13], v[12:13], v[100:101]
  v_lshlrev_b32 v100, 16, v95
  v_and_b32 v101, 0xffff0000, v95
  v_pk_add_f32 v[14:15], v[14:15], v[100:101]
  v_mul_u32_u24 v6, 272, v4
  v_lshl_add_u32 v6, v5, 5, v6
  ds_write_b128 v6, v[8:11]
  ds_write_b128 v6, v[12:15] offset:16
  s_waitcnt lgkmcnt(0)
  s_barrier
  v_and_b32 v2, 63, v0
  v_lshrrev_b32 v3, 6, v0
  v_mul_u32_u24 v6, 2176, v3
  v_lshl_add_u32 v6, v2, 2, v6
  ds_read_b32 v16, v6 offset:0
  ds_read_b32 v17, v6 offset:272
  ds_read_b32 v18, v6 offset:544
  ds_read_b32 v19, v6 offset:816
  ds_read_b32 v20, v6 offset:1088
  ds_read_b32 v21, v6 offset:1360
  ds_read_b32 v22, v6 offset:1632
  ds_read_b32 v23, v6 offset:1904
  s_waitcnt lgkmcnt(0)
  v_add_f32 v16, v16, v17
  v_add_f32 v16, v16, v18
  v_add_f32 v16, v16, v19
  v_add_f32 v16, v16, v20
  v_add_f32 v16, v16, v21
  v_add_f32 v16, v16, v22
  v_add_f32 v16, v16, v23
  s_barrier
  v_lshlrev_b32 v6, 2, v0
  ds_write_b32 v6, v16
  s_waitcnt lgkmcnt(0)
  s_barrier
  v_lshlrev_b32 v6, 2, v2
  ds_read_b32 v16, v6 offset:0
  ds_read_b32 v17, v6 offset:256
  ds_read_b32 v18, v6 offset:512
  ds_read_b32 v19, v6 offset:768
  s_waitcnt lgkmcnt(0)
  v_add_f32 v16, v16, v17
  v_add_f32 v18, v18, v19
  v_add_f32 v16, v16, v18
  v_cvt_pk_bf16_f32 v17, v16, v16
  v_lshlrev_b32 v17, 16, v17
  v_sub_f32 v17, v16, v17
  v_cvt_pk_bf16_f32 v16, v16, v17
  s_waitcnt vmcnt(0)
  v_mov_b32 v201, s62
  v_cmp_eq_u32 vcc, 0, v200
  s_nop 1
  v_cndmask_b32 v200, v200, v201, vcc
  v_cmp_eq_u32 vcc, 0, v0
  s_nop 0
  s_and_saveexec_b64 s[8:9], vcc
  ds_write_b32 v202, v200 offset:60000
  s_mov_b64 exec, s[8:9]
  s_waitcnt lgkmcnt(0)
  s_barrier
  ds_read_b32 v200, v202 offset:60000
  s_waitcnt lgkmcnt(0)
  v_readfirstlane_b32 s62, v200
  s_nop 1
  v_mov_b32 v17, s62
  v_lshlrev_b32 v6, 3, v2
  s_lshl_b32 s4, s3, 9
  v_cmp_gt_u32 vcc, 64, v0
  s_nop 0
  s_and_saveexec_b64 s[8:9], vcc
  buffer_store_dwordx2 v[16:17], v6, s[52:55], s4 offen sc1
  s_mov_b64 exec, s[8:9]
  s_endpgm
l1_kernel_r3:
  s_sub_u32 s3, s2, 288
  s_waitcnt lgkmcnt(0)
  s_add_u32 s3, s3, 224
  s_mov_b32 s48, s18
  s_mov_b32 s49, s19
  s_mov_b32 s50, 163840
  s_mov_b32 s51, 0x20000
  s_mov_b32 s52, s20
  s_mov_b32 s53, s21
  s_mov_b32 s54, 163840
  s_mov_b32 s55, 0x20000
  s_mov_b32 s56, s22
  s_mov_b32 s57, s23
  s_mov_b32 s58, 163840
  s_mov_b32 s59, 0x20000
  s_mov_b32 s60, s24
  s_mov_b32 s61, s25
  s_mov_b32 s62, 163840
  s_mov_b32 s63, 0x20000
  s_mov_b32 s64, s26
  s_mov_b32 s65, s27
  s_mov_b32 s66, 163840
  s_mov_b32 s67, 0x20000
  s_mov_b32 s68, s28
  s_mov_b32 s69, s29
  s_mov_b32 s70, 163840
  s_mov_b32 s71, 0x20000
  s_mov_b32 s72, s30
  s_mov_b32 s73, s31
  s_mov_b32 s74, 1280
  s_mov_b32 s75, 0x20000
  s_mov_b32 s80, s32
  s_mov_b32 s81, s33
  s_mov_b32 s82, 1280
  s_mov_b32 s83, 0x20000
  v_and_b32 v2, 63, v0
  v_lshrrev_b32 v3, 6, v0
  s_nop 0
  v_readfirstlane_b32 s4, v3
  s_lshl_b32 s5, s3, 1
  s_lshr_b32 s6, s4, 1
  s_add_u32 s5, s5, s6
  s_and_b32 s15, s4, 1
  s_lshl_b32 s7, s5, 8
  s_lshl_b32 s6, s15, 7
  s_add_u32 s7, s7, s6
  s_lshl_b32 s8, s5, 1
  v_lshlrev_b32 v4, 1, v2
  v_mov_b32 v5, 0
  buffer_load_ushort v6, v5, s[72:75], s8 offen
  buffer_load_ushort v8, v4, s[48:51], s7 offen nt
  buffer_load_ushort v9, v4, s[52:55], s7 offen nt
  buffer_load_ushort v10, v4, s[56:59], s7 offen nt
  buffer_load_ushort v11, v4, s[60:63], s7 offen nt
  buffer_load_ushort v12, v4, s[64:67], s7 offen nt
  buffer_load_ushort v13, v4, s[68:71], s7 offen nt
  v_cmp_eq_u32 vcc, 0, v2
  v_mov_b32 v120, 0x7f000000
  s_nop 0
  v_cndmask_b32 v120, v120, v5, vcc
  buffer_load_ushort v121, v120, s[80:83], s8 offen
  s_add_u32 s76, s46, 2621440
  s_addc_u32 s77, s47, 0
  s_mov_b32 s78, 2621440
  s_mov_b32 s79, 0x20000
  s_mul_i32 s6, s4, 10240
  v_lshlrev_b32 v20, 2, v2
  v_add_u32 v20, s6, v20
  v_and_b32 v21, 15, v2
  v_mul_u32_u24 v21, 272, v21
  v_lshrrev_b32 v22, 4, v2
  v_lshlrev_b32 v23, 4, v22
  v_add3_u32 v21, v21, v23, s6
  s_mov_b32 s10, 1069066811
  s_mov_b32 s11, 1042479491
  v_and_b32 v23, 15, v2
  s_add_u32 s14, s6, 8704
  v_lshrrev_b32 v122, 1, v22
  v_lshlrev_b32 v122, 8, v122
  v_and_b32 v123, 1, v22
  v_lshl_add_u32 v122, v123, 3, v122
  v_lshl_add_u32 v122, v23, 4, v122
  v_add_u32 v122, s14, v122
  v_cmp_gt_u32 vcc, 2, v22
  v_lshlrev_b32 v123, 3, v23
  v_lshlrev_b32 v124, 2, v23
  v_cndmask_b32 v123, v124, v123, vcc
  v_lshl_add_u32 v123, v22, 7, v123
  v_add_u32 v123, s14, v123
  v_mov_b32 v124, 64
  v_cndmask_b32 v124, v124, 4, vcc
  v_add_u32 v124, v124, v123
  v_lshlrev_b32 v125, 7, v22
  v_lshl_add_u32 v125, v23, 1, v125
  v_add_u32 v125, s14, v125
  s_waitcnt vmcnt(7)
  v_lshlrev_b32 v6, 16, v6
  v_mul_f32 v7, s10, v6
  v_fma_f32 v5, v6, s10, -v7
  v_mov_b32 v36, 849703007
  v_fmac_f32 v5, v6, v36
  v_exp_f32 v7, v7
  v_mul_f32 v5, 1060205080, v5
  v_fmac_f32 v7, v7, v5
  v_cvt_pk_bf16_f32 v7, v7, v7
  v_lshlrev_b32 v7, 16, v7
  s_waitcnt vmcnt(0)
  v_lshlrev_b32 v8, 16, v8
  v_lshlrev_b32 v9, 16, v9
  v_lshlrev_b32 v10, 16, v10
  v_lshlrev_b32 v11, 16, v11
  v_lshlrev_b32 v12, 16, v12
  v_lshlrev_b32 v13, 16, v13
  v_mul_f32 v36, v7, v8
  v_mul_f32 v37, v7, v9
  v_mul_f32 v10, v7, v10
  v_mul_f32 v11, v7, v11
  v_mul_f32 v36, s10, v36
  v_mul_f32 v37, s11, v37
  v_mul_f32 v128, 0x41000000, v36
  v_exp_f32 v130, v36
  v_mul_f32 v132, 0x43000000, v36
  v_mul_f32 v129, 0x41000000, v37
  v_fract_f32 v131, v37
  v_mul_f32 v133, 0x43000000, v37
  v_exp_f32 v128, v128
  v_cos_f32 v46, v131
  v_exp_f32 v132, v132
  v_fract_f32 v129, v129
  v_sin_f32 v47, v131
  v_fract_f32 v133, v133
  v_cos_f32 v44, v129
  v_mul_f32 v46, v130, v46
  v_cos_f32 v60, v133
  v_sin_f32 v45, v129
  v_mul_f32 v47, v130, v47
  v_sin_f32 v61, v133
  v_mul_f32 v44, v128, v44
  v_mul_f32 v134, 0x44800000, v36
  v_mul_f32 v60, v132, v60
  v_mul_f32 v45, -v128, v45
  v_mul_f32 v135, 0x44800000, v37
  v_mul_f32 v61, v132, v61
  v_pk_mul_f32 v[40:41], v[12:13], v[10:11] op_sel:[1,1] op_sel_hi:[1,0] neg_lo:[1,0]
  v_exp_f32 v134, v134
  v_pk_fma_f32 v[38:39], v[12:13], v[10:11], v[40:41] op_sel:[0,0,0] op_sel_hi:[0,1,1]
  v_fract_f32 v135, v135
  v_xor_b32 v39, 0x80000000, v39
  v_cos_f32 v74, v135
  v_sin_f32 v75, v135
  v_mul_f32 v74, v134, v74
  v_mul_f32 v75, v134, v75
  v_cvt_pk_bf16_f32 v100, v38, v39
  v_mov_b32 v103, 0x3f80
  v_pk_mul_f32 v[14:15], v[60:61], v[60:61] op_sel:[1,1] op_sel_hi:[1,0] neg_lo:[1,0]
  ds_write_b32 v20, v100 offset:0
  ds_write_b32 v20, v103 offset:4352
  v_pk_fma_f32 v[62:63], v[60:61], v[60:61], v[14:15] op_sel:[0,0,0] op_sel_hi:[0,1,1]
  v_pk_mul_f32 v[40:41], v[38:39], v[44:45] op_sel:[1,1] op_sel_hi:[1,0] neg_lo:[1,0]
  v_cvt_pk_bf16_f32 v102, v46, v47
  v_pk_mul_f32 v[14:15], v[62:63], v[60:61] op_sel:[1,1] op_sel_hi:[1,0] neg_lo:[1,0]
  v_pk_fma_f32 v[92:93], v[38:39], v[44:45], v[40:41] op_sel:[0,0,0] op_sel_hi:[0,1,1]
  ds_write_b32 v20, v102 offset:4624
  v_pk_fma_f32 v[64:65], v[62:63], v[60:61], v[14:15] op_sel:[0,0,0] op_sel_hi:[0,1,1]
  v_cvt_pk_bf16_f32 v101, v92, v93
  v_pk_mul_f32 v[42:43], v[46:47], v[46:47] op_sel:[1,1] op_sel_hi:[1,0] neg_lo:[1,0]
  v_pk_mul_f32 v[14:15], v[64:65], v[60:61] op_sel:[1,1] op_sel_hi:[1,0] neg_lo:[1,0]
  ds_write_b32 v20, v101 offset:272
  v_pk_fma_f32 v[48:49], v[46:47], v[46:47], v[42:43] op_sel:[0,0,0] op_sel_hi:[0,1,1]
  v_pk_fma_f32 v[66:67], v[64:65], v[60:61], v[14:15] op_sel:[0,0,0] op_sel_hi:[0,1,1]
  v_pk_mul_f32 v[40:41], v[92:93], v[44:45] op_sel:[1,1] op_sel_hi:[1,0] neg_lo:[1,0]
  v_cvt_pk_bf16_f32 v103, v48, v49
  v_pk_mul_f32 v[14:15], v[66:67], v[60:61] op_sel:[1,1] op_sel_hi:[1,0] neg_lo:[1,0]
  v_pk_fma_f32 v[94:95], v[92:93], v[44:45], v[40:41] op_sel:[0,0,0] op_sel_hi:[0,1,1]
  ds_write_b32 v20, v103 offset:4896
  v_pk_fma_f32 v[68:69], v[66:67], v[60:61], v[14:15] op_sel:[0,0,0] op_sel_hi:[0,1,1]
  v_cvt_pk_bf16_f32 v100, v94, v95
  v_pk_mul_f32 v[42:43], v[48:49], v[46:47] op_sel:[1,1] op_sel_hi:[1,0] neg_lo:[1,0]
  v_pk_mul_f32 v[14:15], v[68:69], v[60:61] op_sel:[1,1] op_sel_hi:[1,0] neg_lo:[1,0]
  ds_write_b32 v20, v100 offset:544
  v_pk_fma_f32 v[50:51], v[48:49], v[46:47], v[42:43] op_sel:[0,0,0] op_sel_hi:[0,1,1]
  v_pk_fma_f32 v[70:71], v[68:69], v[60:61], v[14:15] op_sel:[0,0,0] op_sel_hi:[0,1,1]
  v_pk_mul_f32 v[40:41], v[94:95], v[44:45] op_sel:[1,1] op_sel_hi:[1,0] neg_lo:[1,0]
  v_cvt_pk_bf16_f32 v102, v50, v51
  v_pk_mul_f32 v[14:15], v[70:71], v[60:61] op_sel:[1,1] op_sel_hi:[1,0] neg_lo:[1,0]
  v_pk_fma_f32 v[92:93], v[94:95], v[44:45], v[40:41] op_sel:[0,0,0] op_sel_hi:[0,1,1]
  ds_write_b32 v20, v102 offset:5168
  v_pk_fma_f32 v[72:73], v[70:71], v[60:61], v[14:15] op_sel:[0,0,0] op_sel_hi:[0,1,1]
  v_cvt_pk_bf16_f32 v101, v92, v93
  v_pk_mul_f32 v[42:43], v[50:51], v[46:47] op_sel:[1,1] op_sel_hi:[1,0] neg_lo:[1,0]
  v_pk_mul_f32 v[14:15], v[60:61], v[74:75] op_sel:[1,1] op_sel_hi:[1,0] neg_lo:[1,0]
  ds_write_b32 v20, v101 offset:816
  v_pk_fma_f32 v[52:53], v[50:51], v[46:47], v[42:43] op_sel:[0,0,0] op_sel_hi:[0,1,1]
  v_pk_fma_f32 v[76:77], v[60:61], v[74:75], v[14:15] op_sel:[0,0,0] op_sel_hi:[0,1,1]
  v_pk_mul_f32 v[40:41], v[92:93], v[44:45] op_sel:[1,1] op_sel_hi:[1,0] neg_lo:[1,0]
  v_cvt_pk_bf16_f32 v103, v52, v53
  v_pk_mul_f32 v[14:15], v[62:63], v[74:75] op_sel:[1,1] op_sel_hi:[1,0] neg_lo:[1,0]
  v_pk_fma_f32 v[94:95], v[92:93], v[44:45], v[40:41] op_sel:[0,0,0] op_sel_hi:[0,1,1]
  ds_write_b32 v20, v103 offset:5440
  v_pk_fma_f32 v[78:79], v[62:63], v[74:75], v[14:15] op_sel:[0,0,0] op_sel_hi:[0,1,1]
  v_cvt_pk_bf16_f32 v100, v94, v95
  v_pk_mul_f32 v[42:43], v[52:53], v[46:47] op_sel:[1,1] op_sel_hi:[1,0] neg_lo:[1,0]
  v_pk_mul_f32 v[14:15], v[64:65], v[74:75] op_sel:[1,1] op_sel_hi:[1,0] neg_lo:[1,0]
  ds_write_b32 v20, v100 offset:1088
  v_pk_fma_f32 v[54:55], v[52:53], v[46:47], v[42:43] op_sel:[0,0,0] op_sel_hi:[0,1,1]
  v_pk_fma_f32 v[80:81], v[64:65], v[74:75], v[14:15] op_sel:[0,0,0] op_sel_hi:[0,1,1]
  v_pk_mul_f32 v[40:41], v[94:95], v[44:45] op_sel:[1,1] op_sel_hi:[1,0] neg_lo:[1,0]
  v_cvt_pk_bf16_f32 v102, v54, v55
  v_pk_mul_f32 v[14:15], v[66:67], v[74:75] op_sel:[1,1] op_sel_hi:[1,0] neg_lo:[1,0]
  v_pk_fma_f32 v[92:93], v[94:95], v[44:45], v[40:41] op_sel:[0,0,0] op_sel_hi:[0,1,1]
  ds_write_b32 v20, v102 offset:5712
  v_pk_fma_f32 v[82:83], v[66:67], v[74:75], v[14:15] op_sel:[0,0,0] op_sel_hi:[0,1,1]
  v_cvt_pk_bf16_f32 v101, v92, v93
  v_pk_mul_f32 v[42:43], v[54:55], v[46:47] op_sel:[1,1] op_sel_hi:[1,0] neg_lo:[1,0]
  v_pk_mul_f32 v[14:15], v[68:69], v[74:75] op_sel:[1,1] op_sel_hi:[1,0] neg_lo:[1,0]
  ds_write_b32 v20, v101 offset:1360
  v_pk_fma_f32 v[56:57], v[54:55], v[46:47], v[42:43] op_sel:[0,0,0] op_sel_hi:[0,1,1]
  v_pk_fma_f32 v[84:85], v[68:69], v[74:75], v[14:15] op_sel:[0,0,0] op_sel_hi:[0,1,1]
  v_pk_mul_f32 v[40:41], v[92:93], v[44:45] op_sel:[1,1] op_sel_hi:[1,0] neg_lo:[1,0]
  v_cvt_pk_bf16_f32 v103, v56, v57
  v_pk_mul_f32 v[14:15], v[70:71], v[74:75] op_sel:[1,1] op_sel_hi:[1,0] neg_lo:[1,0]
  v_pk_fma_f32 v[94:95], v[92:93], v[44:45], v[40:41] op_sel:[0,0,0] op_sel_hi:[0,1,1]
  ds_write_b32 v20, v103 offset:5984
  v_pk_fma_f32 v[86:87], v[70:71], v[74:75], v[14:15] op_sel:[0,0,0] op_sel_hi:[0,1,1]
  v_cvt_pk_bf16_f32 v100, v94, v95
  v_pk_mul_f32 v[42:43], v[56:57], v[46:47] op_sel:[1,1] op_sel_hi:[1,0] neg_lo:[1,0]
  v_pk_mul_f32 v[14:15], v[72:73], v[74:75] op_sel:[1,1] op_sel_hi:[1,0] neg_lo:[1,0]
  ds_write_b32 v20, v100 offset:1632
  v_pk_fma_f32 v[58:59], v[56:57], v[46:47], v[42:43] op_sel:[0,0,0] op_sel_hi:[0,1,1]
  v_pk_fma_f32 v[88:89], v[72:73], v[74:75], v[14:15] op_sel:[0,0,0] op_sel_hi:[0,1,1]
  v_pk_mul_f32 v[40:41], v[94:95], v[44:45] op_sel:[1,1] op_sel_hi:[1,0] neg_lo:[1,0]
  v_cvt_pk_bf16_f32 v102, v58, v59
  v_pk_mul_f32 v[14:15], v[74:75], v[74:75] op_sel:[1,1] op_sel_hi:[1,0] neg_lo:[1,0]
  v_pk_fma_f32 v[92:93], v[94:95], v[44:45], v[40:41] op_sel:[0,0,0] op_sel_hi:[0,1,1]
  ds_write_b32 v20, v102 offset:6256
  v_pk_fma_f32 v[90:91], v[74:75], v[74:75], v[14:15] op_sel:[0,0,0] op_sel_hi:[0,1,1]
  v_cvt_pk_bf16_f32 v101, v92, v93
  v_cvt_pk_bf16_f32 v103, v60, v61
  ds_write_b32 v20, v101 offset:1904
  ds_write_b32 v20, v103 offset:6528
  v_pk_mul_f32 v[40:41], v[92:93], v[44:45] op_sel:[1,1] op_sel_hi:[1,0] neg_lo:[1,0]
  v_pk_mul_f32 v[42:43], v[60:61], v[46:47] op_sel:[1,1] op_sel_hi:[1,0] neg_lo:[1,0]
  v_pk_fma_f32 v[94:95], v[92:93], v[44:45], v[40:41] op_sel:[0,0,0] op_sel_hi:[0,1,1]
  v_pk_fma_f32 v[98:99], v[60:61], v[46:47], v[42:43] op_sel:[0,0,0] op_sel_hi:[0,1,1]
  v_cvt_pk_bf16_f32 v100, v94, v95
  v_cvt_pk_bf16_f32 v102, v98, v99
  ds_write_b32 v20, v100 offset:2176
  ds_write_b32 v20, v102 offset:6800
  v_pk_mul_f32 v[40:41], v[94:95], v[44:45] op_sel:[1,1] op_sel_hi:[1,0] neg_lo:[1,0]
  v_pk_mul_f32 v[42:43], v[60:61], v[48:49] op_sel:[1,1] op_sel_hi:[1,0] neg_lo:[1,0]
  v_pk_fma_f32 v[92:93], v[94:95], v[44:45], v[40:41] op_sel:[0,0,0] op_sel_hi:[0,1,1]
  v_pk_fma_f32 v[98:99], v[60:61], v[48:49], v[42:43] op_sel:[0,0,0] op_sel_hi:[0,1,1]
  v_cvt_pk_bf16_f32 v101, v92, v93
  v_cvt_pk_bf16_f32 v103, v98, v99
  ds_write_b32 v20, v101 offset:2448
  ds_write_b32 v20, v103 offset:7072
  v_pk_mul_f32 v[40:41], v[92:93], v[44:45] op_sel:[1,1] op_sel_hi:[1,0] neg_lo:[1,0]
  v_pk_mul_f32 v[42:43], v[60:61], v[50:51] op_sel:[1,1] op_sel_hi:[1,0] neg_lo:[1,0]
  v_pk_fma_f32 v[94:95], v[92:93], v[44:45], v[40:41] op_sel:[0,0,0] op_sel_hi:[0,1,1]
  v_pk_fma_f32 v[98:99], v[60:61], v[50:51], v[42:43] op_sel:[0,0,0] op_sel_hi:[0,1,1]
  v_cvt_pk_bf16_f32 v100, v94, v95
  v_cvt_pk_bf16_f32 v102, v98, v99
  ds_write_b32 v20, v100 offset:2720
  ds_write_b32 v20, v102 offset:7344
  v_pk_mul_f32 v[40:41], v[94:95], v[44:45] op_sel:[1,1] op_sel_hi:[1,0] neg_lo:[1,0]
  v_pk_mul_f32 v[42:43], v[60:61], v[52:53] op_sel:[1,1] op_sel_hi:[1,0] neg_lo:[1,0]
  v_pk_fma_f32 v[92:93], v[94:95], v[44:45], v[40:41] op_sel:[0,0,0] op_sel_hi:[0,1,1]
  v_pk_fma_f32 v[98:99], v[60:61], v[52:53], v[42:43] op_sel:[0,0,0] op_sel_hi:[0,1,1]
  v_cvt_pk_bf16_f32 v101, v92, v93
  v_cvt_pk_bf16_f32 v103, v98, v99
  ds_write_b32 v20, v101 offset:2992
  ds_write_b32 v20, v103 offset:7616
  v_pk_mul_f32 v[40:41], v[92:93], v[44:45] op_sel:[1,1] op_sel_hi:[1,0] neg_lo:[1,0]
  v_pk_mul_f32 v[42:43], v[60:61], v[54:55] op_sel:[1,1] op_sel_hi:[1,0] neg_lo:[1,0]
  v_pk_fma_f32 v[94:95], v[92:93], v[44:45], v[40:41] op_sel:[0,0,0] op_sel_hi:[0,1,1]
  v_pk_fma_f32 v[98:99], v[60:61], v[54:55], v[42:43] op_sel:[0,0,0] op_sel_hi:[0,1,1]
  v_cvt_pk_bf16_f32 v100, v94, v95
  v_cvt_pk_bf16_f32 v102, v98, v99
  ds_write_b32 v20, v100 offset:3264
  ds_write_b32 v20, v102 offset:7888
  v_pk_mul_f32 v[40:41], v[94:95], v[44:45] op_sel:[1,1] op_sel_hi:[1,0] neg_lo:[1,0]
  v_pk_mul_f32 v[42:43], v[60:61], v[56:57] op_sel:[1,1] op_sel_hi:[1,0] neg_lo:[1,0]
  v_pk_fma_f32 v[92:93], v[94:95], v[44:45], v[40:41] op_sel:[0,0,0] op_sel_hi:[0,1,1]
  v_pk_fma_f32 v[98:99], v[60:61], v[56:57], v[42:43] op_sel:[0,0,0] op_sel_hi:[0,1,1]
  v_cvt_pk_bf16_f32 v101, v92, v93
  v_cvt_pk_bf16_f32 v103, v98, v99
  ds_write_b32 v20, v101 offset:3536
  ds_write_b32 v20, v103 offset:8160
  v_pk_mul_f32 v[40:41], v[92:93], v[44:45] op_sel:[1,1] op_sel_hi:[1,0] neg_lo:[1,0]
  v_pk_mul_f32 v[42:43], v[60:61], v[58:59] op_sel:[1,1] op_sel_hi:[1,0] neg_lo:[1,0]
  v_pk_fma_f32 v[94:95], v[92:93], v[44:45], v[40:41] op_sel:[0,0,0] op_sel_hi:[0,1,1]
  v_pk_fma_f32 v[98:99], v[60:61], v[58:59], v[42:43] op_sel:[0,0,0] op_sel_hi:[0,1,1]
  v_cvt_pk_bf16_f32 v100, v94, v95
  v_cvt_pk_bf16_f32 v102, v98, v99
  ds_write_b32 v20, v100 offset:3808
  ds_write_b32 v20, v102 offset:8432
  v_pk_mul_f32 v[40:41], v[94:95], v[44:45] op_sel:[1,1] op_sel_hi:[1,0] neg_lo:[1,0]
  v_pk_fma_f32 v[92:93], v[94:95], v[44:45], v[40:41] op_sel:[0,0,0] op_sel_hi:[0,1,1]
  v_cvt_pk_bf16_f32 v101, v92, v93
  ds_write_b32 v20, v101 offset:4080
  ds_read_b128 v[104:107], v21 offset:0
  ds_read_b128 v[108:111], v21 offset:64
  ds_read_b128 v[112:115], v21 offset:128
  ds_read_b128 v[116:119], v21 offset:192
  ds_read_b128 v[128:131], v21 offset:4352
  ds_read_b128 v[132:135], v21 offset:4416
  ds_read_b128 v[136:139], v21 offset:4480
  ds_read_b128 v[140:143], v21 offset:4544
  v_cvt_pk_bf16_f32 v100, v62, v63
  v_cvt_pk_bf16_f32 v103, v66, v67
  v_cvt_pk_bf16_f32 v18, v74, v75
  ds_write_b32 v20, v100 offset:0
  ds_write_b32 v20, v103 offset:2176
  ds_write_b32 v20, v18 offset:4352
  v_pk_mul_f32 v[40:41], v[62:63], v[48:49] op_sel:[1,1] op_sel_hi:[1,0] neg_lo:[1,0]
  v_pk_mul_f32 v[42:43], v[66:67], v[52:53] op_sel:[1,1] op_sel_hi:[1,0] neg_lo:[1,0]
  v_cvt_pk_bf16_f32 v19, v76, v77
  v_pk_fma_f32 v[96:97], v[62:63], v[48:49], v[40:41] op_sel:[0,0,0] op_sel_hi:[0,1,1]
  v_pk_fma_f32 v[98:99], v[66:67], v[52:53], v[42:43] op_sel:[0,0,0] op_sel_hi:[0,1,1]
  ds_write_b32 v20, v19 offset:4624
  v_cvt_pk_bf16_f32 v101, v96, v97
  v_cvt_pk_bf16_f32 v102, v98, v99
  v_cvt_pk_bf16_f32 v18, v78, v79
  ds_write_b32 v20, v101 offset:272
  ds_write_b32 v20, v102 offset:2448
  ds_write_b32 v20, v18 offset:4896
  v_pk_mul_f32 v[40:41], v[62:63], v[52:53] op_sel:[1,1] op_sel_hi:[1,0] neg_lo:[1,0]
  v_cvt_pk_bf16_f32 v103, v68, v69
  v_cvt_pk_bf16_f32 v19, v80, v81
  v_pk_fma_f32 v[96:97], v[62:63], v[52:53], v[40:41] op_sel:[0,0,0] op_sel_hi:[0,1,1]
  ds_write_b32 v20, v103 offset:2720
  ds_write_b32 v20, v19 offset:5168
  v_cvt_pk_bf16_f32 v100, v96, v97
  v_pk_mul_f32 v[42:43], v[68:69], v[52:53] op_sel:[1,1] op_sel_hi:[1,0] neg_lo:[1,0]
  v_cvt_pk_bf16_f32 v18, v82, v83
  ds_write_b32 v20, v100 offset:544
  v_pk_fma_f32 v[98:99], v[68:69], v[52:53], v[42:43] op_sel:[0,0,0] op_sel_hi:[0,1,1]
  ds_write_b32 v20, v18 offset:5440
  v_pk_mul_f32 v[40:41], v[62:63], v[56:57] op_sel:[1,1] op_sel_hi:[1,0] neg_lo:[1,0]
  v_cvt_pk_bf16_f32 v102, v98, v99
  v_cvt_pk_bf16_f32 v19, v84, v85
  v_pk_fma_f32 v[96:97], v[62:63], v[56:57], v[40:41] op_sel:[0,0,0] op_sel_hi:[0,1,1]
  ds_write_b32 v20, v102 offset:2992
  ds_write_b32 v20, v19 offset:5712
  v_cvt_pk_bf16_f32 v101, v96, v97
  v_cvt_pk_bf16_f32 v103, v70, v71
  v_cvt_pk_bf16_f32 v18, v86, v87
  ds_write_b32 v20, v101 offset:816
  ds_write_b32 v20, v103 offset:3264
  ds_write_b32 v20, v18 offset:5984
  v_cvt_pk_bf16_f32 v100, v64, v65
  v_pk_mul_f32 v[42:43], v[70:71], v[52:53] op_sel:[1,1] op_sel_hi:[1,0] neg_lo:[1,0]
  v_cvt_pk_bf16_f32 v19, v88, v89
  ds_write_b32 v20, v100 offset:1088
  v_pk_fma_f32 v[98:99], v[70:71], v[52:53], v[42:43] op_sel:[0,0,0] op_sel_hi:[0,1,1]
  ds_write_b32 v20, v19 offset:6256
  v_pk_mul_f32 v[40:41], v[64:65], v[48:49] op_sel:[1,1] op_sel_hi:[1,0] neg_lo:[1,0]
  v_cvt_pk_bf16_f32 v102, v98, v99
  v_cvt_pk_bf16_f32 v18, v90, v91
  v_pk_fma_f32 v[96:97], v[64:65], v[48:49], v[40:41] op_sel:[0,0,0] op_sel_hi:[0,1,1]
  ds_write_b32 v20, v102 offset:3536
  ds_write_b32 v20, v18 offset:6528
  v_cvt_pk_bf16_f32 v101, v96, v97
  v_cvt_pk_bf16_f32 v103, v72, v73
  ds_write_b32 v20, v101 offset:1360
  ds_write_b32 v20, v103 offset:3808
  v_pk_mul_f32 v[40:41], v[64:65], v[52:53] op_sel:[1,1] op_sel_hi:[1,0] neg_lo:[1,0]
  v_pk_mul_f32 v[42:43], v[72:73], v[52:53] op_sel:[1,1] op_sel_hi:[1,0] neg_lo:[1,0]
  v_pk_fma_f32 v[96:97], v[64:65], v[52:53], v[40:41] op_sel:[0,0,0] op_sel_hi:[0,1,1]
  v_pk_fma_f32 v[98:99], v[72:73], v[52:53], v[42:43] op_sel:[0,0,0] op_sel_hi:[0,1,1]
  v_cvt_pk_bf16_f32 v100, v96, v97
  v_cvt_pk_bf16_f32 v102, v98, v99
  ds_write_b32 v20, v100 offset:1632
  ds_write_b32 v20, v102 offset:4080
  v_pk_mul_f32 v[40:41], v[64:65], v[56:57] op_sel:[1,1] op_sel_hi:[1,0] neg_lo:[1,0]
  v_pk_fma_f32 v[96:97], v[64:65], v[56:57], v[40:41] op_sel:[0,0,0] op_sel_hi:[0,1,1]
  v_cvt_pk_bf16_f32 v101, v96, v97
  ds_write_b32 v20, v101 offset:1904
  ds_read_b128 v[144:147], v21 offset:0
  ds_read_b128 v[148:151], v21 offset:64
  ds_read_b128 v[152:155], v21 offset:128
  ds_read_b128 v[156:159], v21 offset:192
  s_waitcnt lgkmcnt(15)
  v_mfma_f32_16x16x32_bf16 v[24:27], v[128:131], v[104:107], 0
  v_mfma_f32_16x16x32_bf16 v[24:27], v[132:135], v[108:111], v[24:27]
  v_mfma_f32_16x16x32_bf16 v[24:27], v[136:139], v[112:115], v[24:27]
  v_mfma_f32_16x16x32_bf16 v[24:27], v[140:143], v[116:119], v[24:27]
  ds_read_b128 v[46:49], v21 offset:4352
  ds_read_b128 v[50:53], v21 offset:4416
  ds_read_b128 v[54:57], v21 offset:4480
  ds_read_b128 v[58:61], v21 offset:4544
  s_waitcnt lgkmcnt(4)
  v_mfma_f32_16x16x32_bf16 v[28:31], v[144:147], v[104:107], 0
  v_mfma_f32_16x16x32_bf16 v[28:31], v[148:151], v[108:111], v[28:31]
  v_mfma_f32_16x16x32_bf16 v[28:31], v[152:155], v[112:115], v[28:31]
  v_mfma_f32_16x16x32_bf16 v[28:31], v[156:159], v[116:119], v[28:31]
  s_waitcnt lgkmcnt(0)
  v_mfma_f32_16x16x32_bf16 v[32:35], v[46:49], v[104:107], 0
  v_mfma_f32_16x16x32_bf16 v[32:35], v[50:53], v[108:111], v[32:35]
  v_mfma_f32_16x16x32_bf16 v[32:35], v[54:57], v[112:115], v[32:35]
  v_mfma_f32_16x16x32_bf16 v[32:35], v[58:61], v[116:119], v[32:35]
  v_lshlrev_b32 v46, 4, v2
  v_add_u32 v47, s6, v46
  s_cmp_eq_u32 s15, 0
  s_cbranch_scc1 kgh0_11
  ds_write_b128 v47, v[24:27] offset:0
  ds_write_b128 v47, v[28:31] offset:1024
  s_nop 1
  ds_write_b128 v47, v[32:35] offset:2048
  s_waitcnt lgkmcnt(0)
  s_barrier
  s_branch kgdone_10
kgh0_11:
  s_barrier
  ds_read_b128 v[48:51], v47 offset:10240
  ds_read_b128 v[52:55], v47 offset:11264
  ds_read_b128 v[56:59], v47 offset:12288
  s_waitcnt lgkmcnt(0)
  v_pk_add_f32 v[24:25], v[24:25], v[48:49]
  v_pk_add_f32 v[26:27], v[26:27], v[50:51]
  v_pk_add_f32 v[28:29], v[28:29], v[52:53]
  v_pk_add_f32 v[30:31], v[30:31], v[54:55]
  v_pk_add_f32 v[32:33], v[32:33], v[56:57]
  v_pk_add_f32 v[34:35], v[34:35], v[58:59]
  v_lshlrev_b32 v121, 16, v121
  v_add_f32 v24, v24, v121
  v_cvt_pk_bf16_f32 v40, v24, v25
  v_cvt_pk_bf16_f32 v41, v26, v27
  ds_write_b64 v122, v[40:41]
  v_cvt_pk_bf16_f32 v42, v28, v29
  v_cvt_pk_bf16_f32 v43, v30, v31
  ds_write_b32 v123, v42 offset:512
  ds_write_b32 v124, v43 offset:512
  v_cvt_pk_bf16_f32 v44, v32, v33
  v_cvt_pk_bf16_f32 v45, v34, v35
  ds_write_b16 v125, v44 offset:1024
  ds_write_b16_d16_hi v125, v44 offset:1056
  ds_write_b16 v125, v45 offset:1088
  ds_write_b16_d16_hi v125, v45 offset:1120
  v_cmp_gt_u32 vcc, 32, v2
  v_lshlrev_b32 v46, 4, v2
  v_lshlrev_b32 v47, 3, v2
  v_add_u32 v47, 256, v47
  v_cndmask_b32 v47, v47, v46, vcc
  v_add_u32 v47, s14, v47
  ds_read2_b64 v[48:51], v47 offset0:0 offset1:1
  v_lshlrev_b32 v47, 2, v2
  v_add_u32 v47, s14, v47
  ds_read2_b32 v[52:53], v47 offset0:192 offset1:193
  v_add_u32 v47, s14, v4
  ds_read_u16 v54, v47 offset:1024
  ds_read_u16 v55, v47 offset:1026
  ds_read_u16 v56, v47 offset:1152
  ds_read_u16 v57, v47 offset:1154
  v_mov_b32 v58, 0x01000100
  v_mov_b32 v59, 0x03020100
  v_cndmask_b32 v58, v58, v59, vcc
  v_mov_b32 v59, 0x05040302
  v_mov_b32 v60, 0x07060504
  v_cndmask_b32 v59, v59, v60, vcc
  v_mov_b32 v61, 0x01000100
  v_cndmask_b32 v60, v61, v60, vcc
  s_mov_b32 s9, 0x05040302
  s_mov_b32 s12, 0x01000100
  s_mov_b32 s13, 0x03020302
  v_and_b32 v61, 1, v2
  v_mul_u32_u24 v61, 0x0404, v61
  v_add_u32 v61, 0x05040100, v61
  s_lshl_b32 s7, s5, 12
  s_waitcnt lgkmcnt(5)
  v_perm_b32 v64, v49, v48, v58
  v_perm_b32 v65, v49, v48, v59
  v_perm_b32 v66, v50, v49, v60
  v_perm_b32 v67, v50, v49, s9
  v_cndmask_b32 v67, v67, v51, vcc
  buffer_store_dwordx4 v[64:67], v46, s[76:79], s7 offen sc1
  s_waitcnt lgkmcnt(4)
  v_perm_b32 v68, v52, v52, s12
  v_mov_b32 v69, v52
  v_perm_b32 v70, v52, v52, s13
  v_perm_b32 v71, v53, v53, s12
  buffer_store_dwordx4 v[68:71], v46, s[76:79], s7 offen offset:1024 sc1
  s_waitcnt lgkmcnt(0)
  v_perm_b32 v72, v54, v54, s12
  v_perm_b32 v73, v54, v54, s12
  v_perm_b32 v74, v55, v54, v61
  v_perm_b32 v75, v55, v55, s12
  buffer_store_dwordx4 v[72:75], v46, s[76:79], s7 offen offset:2048 sc1
  v_perm_b32 v76, v56, v56, s12
  v_perm_b32 v77, v56, v56, s12
  v_perm_b32 v78, v57, v56, v61
  v_perm_b32 v79, v57, v57, s12
  buffer_store_dwordx4 v[76:79], v46, s[76:79], s7 offen offset:3072 sc1
kgdone_10:
  s_endpgm
l1_kernel_r4:
  s_sub_u32 s3, s2, 384
  s_waitcnt lgkmcnt(0)
  s_mov_b32 s48, s40
  s_mov_b32 s49, s41
  s_mov_b32 s50, 2211840
  s_mov_b32 s51, 0x20000
  s_add_u32 s52, s46, 5242880
  s_addc_u32 s53, s47, 0
  s_mov_b32 s54, 2211840
  s_mov_b32 s55, 0x20000
  s_lshl_b32 s4, s3, 5
  v_and_b32 v2, 63, v0
  v_lshrrev_b32 v3, 6, v0
  v_lshrrev_b32 v4, 3, v0
  v_and_b32 v5, 7, v0
  v_lshlrev_b32 v5, 4, v5
  v_add_u32 v6, s4, v4
  v_mul_u32_u24 v6, 1280, v6
  v_add_u32 v6, v6, v5
  buffer_load_dwordx4 v[16:19], v6, s[48:51], 0 offen offset:0 nt
  buffer_load_dwordx4 v[20:23], v6, s[48:51], 0 offen offset:128 nt
  buffer_load_dwordx4 v[24:27], v6, s[48:51], 0 offen offset:256 nt
  buffer_load_dwordx4 v[28:31], v6, s[48:51], 0 offen offset:384 nt
  buffer_load_dwordx4 v[32:35], v6, s[48:51], 0 offen offset:512 nt
  buffer_load_dwordx4 v[36:39], v6, s[48:51], 0 offen offset:640 nt
  buffer_load_dwordx4 v[40:43], v6, s[48:51], 0 offen offset:768 nt
  buffer_load_dwordx4 v[44:47], v6, s[48:51], 0 offen offset:896 nt
  buffer_load_dwordx4 v[48:51], v6, s[48:51], 0 offen offset:1024 nt
  buffer_load_dwordx4 v[52:55], v6, s[48:51], 0 offen offset:1152 nt
  v_mul_u32_u24 v1, 1296, v4
  v_add_u32 v1, v1, v5
  s_waitcnt vmcnt(9)
  ds_write_b128 v1, v[16:19] offset:0
  s_waitcnt vmcnt(8)
  ds_write_b128 v1, v[20:23] offset:128
  s_waitcnt vmcnt(7)
  ds_write_b128 v1, v[24:27] offset:256
  s_waitcnt vmcnt(6)
  ds_write_b128 v1, v[28:31] offset:384
  s_waitcnt vmcnt(5)
  ds_write_b128 v1, v[32:35] offset:512
  s_waitcnt vmcnt(4)
  ds_write_b128 v1, v[36:39] offset:640
  s_waitcnt vmcnt(3)
  ds_write_b128 v1, v[40:43] offset:768
  s_waitcnt vmcnt(2)
  ds_write_b128 v1, v[44:47] offset:896
  s_waitcnt vmcnt(1)
  ds_write_b128 v1, v[48:51] offset:1024
  s_waitcnt vmcnt(0)
  ds_write_b128 v1, v[52:55] offset:1152
  s_waitcnt lgkmcnt(0)
  s_barrier
  v_lshrrev_b32 v4, 4, v2
  v_bfe_u32 v5, v2, 2, 2
  v_lshlrev_b32 v4, 3, v4
  v_add_u32 v5, v5, v4
  v_mul_u32_u24 v5, 1296, v5
  v_and_b32 v6, 3, v2
  v_lshlrev_b32 v6, 3, v6
  v_add_u32 v5, v5, v6
  v_lshlrev_b32 v6, 5, v3
  v_add_u32 v5, v5, v6
  v_mul_u32_u24 v6, 55296, v3
  v_lshlrev_b32 v7, 4, v2
  v_add_u32 v6, v6, v7
  s_lshl_b32 s4, s3, 10
  ds_read_b64_tr_b16 v[16:17], v5 offset:0
  ds_read_b64_tr_b16 v[18:19], v5 offset:5184
  ds_read_b64_tr_b16 v[20:21], v5 offset:128
  ds_read_b64_tr_b16 v[22:23], v5 offset:5312
  ds_read_b64_tr_b16 v[24:25], v5 offset:256
  ds_read_b64_tr_b16 v[26:27], v5 offset:5440
  ds_read_b64_tr_b16 v[28:29], v5 offset:384
  ds_read_b64_tr_b16 v[30:31], v5 offset:5568
  ds_read_b64_tr_b16 v[32:33], v5 offset:512
  ds_read_b64_tr_b16 v[34:35], v5 offset:5696
  ds_read_b64_tr_b16 v[36:37], v5 offset:640
  ds_read_b64_tr_b16 v[38:39], v5 offset:5824
  ds_read_b64_tr_b16 v[40:41], v5 offset:768
  ds_read_b64_tr_b16 v[42:43], v5 offset:5952
  ds_read_b64_tr_b16 v[44:45], v5 offset:896
  ds_read_b64_tr_b16 v[46:47], v5 offset:6080
  ds_read_b64_tr_b16 v[48:49], v5 offset:1024
  ds_read_b64_tr_b16 v[50:51], v5 offset:6208
  ds_read_b64_tr_b16 v[52:53], v5 offset:1152
  ds_read_b64_tr_b16 v[54:55], v5 offset:6336
  s_waitcnt lgkmcnt(15)
  buffer_store_dwordx4 v[16:19], v6, s[52:55], s4 offen sc1
  s_add_u32 s4, s4, 221184
  s_waitcnt lgkmcnt(15)
  buffer_store_dwordx4 v[20:23], v6, s[52:55], s4 offen sc1
  s_add_u32 s4, s4, 221184
  s_waitcnt lgkmcnt(14)
  buffer_store_dwordx4 v[24:27], v6, s[52:55], s4 offen sc1
  s_add_u32 s4, s4, 221184
  s_waitcnt lgkmcnt(12)
  buffer_store_dwordx4 v[28:31], v6, s[52:55], s4 offen sc1
  s_add_u32 s4, s4, 221184
  s_waitcnt lgkmcnt(10)
  buffer_store_dwordx4 v[32:35], v6, s[52:55], s4 offen sc1
  s_add_u32 s4, s4, 221184
  s_waitcnt lgkmcnt(8)
  buffer_store_dwordx4 v[36:39], v6, s[52:55], s4 offen sc1
  s_add_u32 s4, s4, 221184
  s_waitcnt lgkmcnt(6)
  buffer_store_dwordx4 v[40:43], v6, s[52:55], s4 offen sc1
  s_add_u32 s4, s4, 221184
  s_waitcnt lgkmcnt(4)
  buffer_store_dwordx4 v[44:47], v6, s[52:55], s4 offen sc1
  s_add_u32 s4, s4, 221184
  s_waitcnt lgkmcnt(2)
  buffer_store_dwordx4 v[48:51], v6, s[52:55], s4 offen sc1
  s_add_u32 s4, s4, 221184
  s_waitcnt lgkmcnt(0)
  buffer_store_dwordx4 v[52:55], v6, s[52:55], s4 offen sc1
  s_endpgm
l1_kernel_r5:
  s_sub_u32 s3, s2, 438
  s_waitcnt lgkmcnt(0)
  s_cmp_ge_u32 s3, 10
  s_cbranch_scc1 misce_12
  s_cmp_lt_u32 s3, 2
  s_cbranch_scc1 misce_12_z
  s_getpc_b64 s[12:13]
pc_13:
  s_sub_u32 s12, s12, pc_13-code_start
  s_subb_u32 s13, s13, 0
  v_lshlrev_b32 v6, 7, v0
  v_add_u32 v7, 0, v6
  v_min_u32 v7, code_end-code_start-4, v7
  global_load_dword v8, v7, s[12:13]
  v_add_u32 v7, 32768, v6
  v_min_u32 v7, code_end-code_start-4, v7
  global_load_dword v8, v7, s[12:13]
  s_endpgm
misce_12_z:
  s_add_u32 s48, s46, 21102592
  s_addc_u32 s49, s47, 0
  s_mov_b32 s50, 4096
  s_mov_b32 s51, 0x20000
  v_lshlrev_b32 v4, 3, v0
  v_mov_b32 v6, 0
  v_mov_b32 v7, 0
  buffer_store_dwordx2 v[6:7], v4, s[48:51], 0 offen
misce_12:
  s_endpgm
l1_kernel_r6:
  s_sub_u32 s3, s2, 480
  s_waitcnt lgkmcnt(0)
  s_add_u32 s3, s3, 32
  s_branch l1_lnt_entry

.globl l2_kernel
.p2align 8
.type l2_kernel,@function
l2_kernel:
  s_load_dwordx16 s[16:31], s[0:1], 0
  s_load_dwordx16 s[32:47], s[0:1], 64
  s_cmp_lt_u32 s2, 160
  s_cbranch_scc1 l2_kernel_r0
  s_cmp_lt_u32 s2, 416
  s_cbranch_scc1 l2_kernel_r1
  s_endpgm
l2_kernel_r0:
  s_sub_u32 s3, s2, 0
  s_waitcnt lgkmcnt(0)
  s_setprio 3
  s_add_u32 s52, s46, 2621440
  s_addc_u32 s53, s47, 0
  s_mov_b32 s54, 2621440
  s_mov_b32 s55, 0x20000
  v_and_b32 v2, 63, v0
  v_lshrrev_b32 v3, 6, v0
  s_nop 0
  v_readfirstlane_b32 s4, v3
  s_lshl_b32 s5, s3, 2
  s_add_u32 s5, s5, s4
  s_mul_i32 s6, s4, 12800
  s_lshl_b32 s7, s5, 12
  s_lshl_b32 s8, s5, 1
  v_lshlrev_b32 v4, 4, v2
  v_mov_b32 v5, 0
  buffer_load_dwordx4 v[16:19], v4, s[52:55], s7 offen offset:0
  buffer_load_dwordx4 v[20:23], v4, s[52:55], s7 offen offset:1024
  buffer_load_dwordx4 v[24:27], v4, s[52:55], s7 offen offset:2048
  buffer_load_dwordx4 v[28:31], v4, s[52:55], s7 offen offset:3072
  s_mov_b32 s76, s46
  s_mov_b32 s77, s47
  s_mov_b32 s78, 2621440
  s_mov_b32 s79, 0x20000
  v_lshrrev_b32 v180, 4, v2
  v_and_b32 v181, 15, v2
  v_mul_u32_u24 v182, 40960, v180
  v_lshl_add_u32 v182, v181, 4, v182
  s_mul_i32 s10, s4, 655360
  s_lshl_b32 s11, s3, 8
  s_add_u32 s10, s10, s11
  buffer_load_dwordx4 v[200:203], v182, s[76:79], s10 offen
  s_add_u32 s10, s10, 163840
  buffer_load_dwordx4 v[204:207], v182, s[76:79], s10 offen
  s_add_u32 s10, s10, 163840
  buffer_load_dwordx4 v[208:211], v182, s[76:79], s10 offen
  s_add_u32 s10, s10, 163840
  buffer_load_dwordx4 v[212:215], v182, s[76:79], s10 offen
  v_lshrrev_b32 v182, 2, v181
  v_mul_u32_u24 v182, 12800, v182
  v_lshl_add_u32 v182, v180, 6, v182
  v_and_b32 v181, 3, v181
  v_lshl_add_u32 v182, v181, 4, v182
  s_lshl_b32 s10, s4, 10
  v_add_u32 v182, s10, v182
  v_lshlrev_b32 v183, 4, v2
  v_add_u32 v183, s6, v183
  v_mov_b32 v184, 0
  v_mov_b32 v185, 0
  v_mov_b32 v186, 0
  v_mov_b32 v187, 0
  v_cmp_gt_u32 vcc, 28, v2
  s_nop 0
  s_and_saveexec_b64 s[12:13], vcc
  ds_write_b128 v183, v[184:187] offset:8256
  ds_write_b128 v183, v[184:187] offset:4096
  s_mov_b64 exec, s[12:13]
  s_waitcnt vmcnt(4)
  ds_write_b128 v183, v[16:19] offset:4160
  ds_write_b128 v183, v[20:23] offset:5184
  ds_write_b128 v183, v[24:27] offset:6208
  ds_write_b128 v183, v[28:31] offset:7232
  s_waitcnt vmcnt(0)
  ds_write_b128 v182, v[200:203] offset:8704
  ds_write_b128 v182, v[204:207] offset:8960
  ds_write_b128 v182, v[208:211] offset:9216
  ds_write_b128 v182, v[212:215] offset:9472
  s_add_u32 s56, s46, 16777216
  s_addc_u32 s57, s47, 0
  s_mov_b32 s58, 2621440
  s_mov_b32 s59, 0x20000
  v_and_b32 v7, 31, v2
  v_lshrrev_b32 v8, 2, v7
  v_lshrrev_b32 v10, 5, v2
  v_add_u32 v8, v8, v10
  v_and_b32 v7, 3, v2
  v_lshlrev_b32 v8, 6, v8
  v_lshl_add_u32 v8, v7, 4, v8
  v_add_u32 v10, s6, v8
  v_bfe_u32 v13, v2, 4, 1
  v_lshlrev_b32 v13, 4, v13
  v_and_b32 v14, 3, v2
  v_lshl_add_u32 v13, v14, 2, v13
  v_bfe_u32 v14, v2, 2, 2
  v_lshlrev_b32 v14, 2, v14
  v_sub_u32 v13, v13, v14
  v_lshrrev_b32 v14, 5, v2
  v_lshlrev_b32 v14, 5, v14
  v_sub_u32 v13, v13, v14
  v_add_u32 v13, 48, v13
  v_lshl_add_u32 v13, v13, 1, s6
  v_lshl_add_u32 v14, v2, 1, s6
  v_lshlrev_b32 v4, 4, v2
  v_add_u32 v12, s6, v4
  v_mov_b32 v104, 0
  v_mov_b32 v105, 0
  v_mov_b32 v106, 0
  s_waitcnt lgkmcnt(0)
  s_barrier
  s_setprio 0
  ds_read_b64_tr_b16 v[16:17], v13 offset:4128
  ds_read_b64_tr_b16 v[18:19], v13 offset:4096
  ds_read_b128 v[32:35], v10 offset:8640
  ds_read_b128 v[36:39], v10 offset:9152
  ds_read_b128 v[40:43], v10 offset:9664
  ds_read_b128 v[44:47], v10 offset:10176
  ds_read_b64_tr_b16 v[20:21], v13 offset:4256
  ds_read_b64_tr_b16 v[22:23], v13 offset:4224
  ds_read_b128 v[48:51], v10 offset:8512
  ds_read_b128 v[52:55], v10 offset:9024
  ds_read_b128 v[56:59], v10 offset:9536
  ds_read_b128 v[60:63], v10 offset:10048
  ds_read_b64_tr_b16 v[24:25], v13 offset:4384
  ds_read_b64_tr_b16 v[26:27], v13 offset:4352
  s_waitcnt lgkmcnt(8)
  v_mfma_f32_32x32x16_bf16 v[128:143], v[32:35], v[16:19], 0
  v_mfma_f32_32x32x16_bf16 v[144:159], v[36:39], v[16:19], 0
  v_mfma_f32_32x32x16_bf16 v[160:175], v[40:43], v[16:19], 0
  v_mfma_f32_32x32x16_bf16 v[176:191], v[44:47], v[16:19], 0
  ds_read_b64_tr_b16 v[28:29], v13 offset:4512
  ds_read_b64_tr_b16 v[30:31], v13 offset:4480
  ds_read_b128 v[64:67], v10 offset:8384
  ds_read_b128 v[68:71], v10 offset:8896
  ds_read_b128 v[72:75], v10 offset:9408
  ds_read_b128 v[76:79], v10 offset:9920
  s_waitcnt lgkmcnt(8)
  v_mfma_f32_32x32x16_bf16 v[128:143], v[48:51], v[20:23], v[128:143]
  v_mfma_f32_32x32x16_bf16 v[144:159], v[52:55], v[20:23], v[144:159]
  v_mfma_f32_32x32x16_bf16 v[160:175], v[56:59], v[20:23], v[160:175]
  v_mfma_f32_32x32x16_bf16 v[176:191], v[60:63], v[20:23], v[176:191]
  ds_read_b64_tr_b16 v[16:17], v13 offset:4640
  ds_read_b64_tr_b16 v[18:19], v13 offset:4608
  ds_read_b128 v[80:83], v10 offset:8256
  ds_read_b128 v[84:87], v10 offset:8768
  ds_read_b128 v[88:91], v10 offset:9280
  ds_read_b128 v[92:95], v10 offset:9792
  s_waitcnt lgkmcnt(6)
  v_mfma_f32_32x32x16_bf16 v[128:143], v[64:67], v[24:27], v[128:143]
  v_mfma_f32_32x32x16_bf16 v[144:159], v[68:71], v[24:27], v[144:159]
  v_mfma_f32_32x32x16_bf16 v[160:175], v[72:75], v[24:27], v[160:175]
  v_mfma_f32_32x32x16_bf16 v[176:191], v[76:79], v[24:27], v[176:191]
  ds_read_b64_tr_b16 v[20:21], v13 offset:4768
  ds_read_b64_tr_b16 v[22:23], v13 offset:4736
  s_waitcnt lgkmcnt(2)
  v_mfma_f32_32x32x16_bf16 v[128:143], v[80:83], v[28:31], v[128:143]
  v_mfma_f32_32x32x16_bf16 v[144:159], v[84:87], v[28:31], v[144:159]
  v_mfma_f32_32x32x16_bf16 v[160:175], v[88:91], v[28:31], v[160:175]
  s_nop 9
  v_add_f32_dpp v112, v104, v130 wave_ror:1 row_mask:0xf bank_mask:0xf
  v_add_f32_dpp v116, v131, v134 wave_ror:1 row_mask:0xf bank_mask:0xf
  v_add_f32_dpp v120, v135, v138 wave_ror:1 row_mask:0xf bank_mask:0xf
  v_mfma_f32_32x32x16_bf16 v[176:191], v[92:95], v[28:31], v[176:191]
  v_add_f32_dpp v124, v139, v142 wave_ror:1 row_mask:0xf bank_mask:0xf
  v_add_f32_dpp v112, v131, v130 wave_shr:1 row_mask:0xf bank_mask:0xf
  v_add_f32_dpp v116, v135, v134 wave_shr:1 row_mask:0xf bank_mask:0xf
  ds_read_b64_tr_b16 v[24:25], v13 offset:4896
  ds_read_b64_tr_b16 v[26:27], v13 offset:4864
  v_mfma_f32_32x32x16_bf16 v[144:159], v[32:35], v[16:19], v[144:159]
  v_add_f32_dpp v120, v139, v138 wave_shr:1 row_mask:0xf bank_mask:0xf
  v_add_f32_dpp v124, v143, v142 wave_shr:1 row_mask:0xf bank_mask:0xf
  v_add_f32_dpp v113, v105, v129 wave_ror:1 row_mask:0xf bank_mask:0xf
  v_mfma_f32_32x32x16_bf16 v[160:175], v[36:39], v[16:19], v[160:175]
  v_add_f32_dpp v117, v112, v133 wave_ror:1 row_mask:0xf bank_mask:0xf
  v_add_f32_dpp v121, v116, v137 wave_ror:1 row_mask:0xf bank_mask:0xf
  v_add_f32_dpp v125, v120, v141 wave_ror:1 row_mask:0xf bank_mask:0xf
  v_mfma_f32_32x32x16_bf16 v[176:191], v[40:43], v[16:19], v[176:191]
  v_add_f32_dpp v113, v112, v129 wave_shr:1 row_mask:0xf bank_mask:0xf
  v_add_f32_dpp v117, v116, v133 wave_shr:1 row_mask:0xf bank_mask:0xf
  v_add_f32_dpp v121, v120, v137 wave_shr:1 row_mask:0xf bank_mask:0xf
  ds_read_b64_tr_b16 v[28:29], v13 offset:5024
  ds_read_b64_tr_b16 v[30:31], v13 offset:4992
  s_waitcnt lgkmcnt(4)
  v_mfma_f32_32x32x16_bf16 v[144:159], v[48:51], v[20:23], v[144:159]
  v_add_f32_dpp v125, v124, v141 wave_shr:1 row_mask:0xf bank_mask:0xf
  v_add_f32_dpp v114, v106, v128 wave_ror:1 row_mask:0xf bank_mask:0xf
  v_add_f32_dpp v118, v113, v132 wave_ror:1 row_mask:0xf bank_mask:0xf
  v_mfma_f32_32x32x16_bf16 v[160:175], v[52:55], v[20:23], v[160:175]
  v_add_f32_dpp v122, v117, v136 wave_ror:1 row_mask:0xf bank_mask:0xf
  v_add_f32_dpp v126, v121, v140 wave_ror:1 row_mask:0xf bank_mask:0xf
  v_add_f32_dpp v114, v113, v128 wave_shr:1 row_mask:0xf bank_mask:0xf
  v_mfma_f32_32x32x16_bf16 v[176:191], v[56:59], v[20:23], v[176:191]
  v_add_f32_dpp v118, v117, v132 wave_shr:1 row_mask:0xf bank_mask:0xf
  v_add_f32_dpp v122, v121, v136 wave_shr:1 row_mask:0xf bank_mask:0xf
  v_add_f32_dpp v126, v125, v140 wave_shr:1 row_mask:0xf bank_mask:0xf
  ds_read_b64_tr_b16 v[16:17], v13 offset:5152
  ds_read_b64_tr_b16 v[18:19], v13 offset:5120
  s_waitcnt lgkmcnt(4)
  v_mfma_f32_32x32x16_bf16 v[144:159], v[64:67], v[24:27], v[144:159]
  v_cvt_pk_bf16_f32 v108, v114, v118
  v_cvt_pk_bf16_f32 v109, v122, v126
  ds_write_b16 v14, v108 offset:0
  v_mfma_f32_32x32x16_bf16 v[160:175], v[68:71], v[24:27], v[160:175]
  ds_write_b16_d16_hi v14, v108 offset:128
  ds_write_b16 v14, v109 offset:256
  ds_write_b16_d16_hi v14, v109 offset:384
  v_mfma_f32_32x32x16_bf16 v[176:191], v[72:75], v[24:27], v[176:191]
  ds_read_b64_tr_b16 v[20:21], v13 offset:5280
  ds_read_b64_tr_b16 v[22:23], v13 offset:5248
  s_waitcnt lgkmcnt(8)
  v_mfma_f32_32x32x16_bf16 v[144:159], v[80:83], v[28:31], v[144:159]
  v_mfma_f32_32x32x16_bf16 v[160:175], v[84:87], v[28:31], v[160:175]
  v_mfma_f32_32x32x16_bf16 v[176:191], v[88:91], v[28:31], v[176:191]
  s_nop 9
  v_add_f32_dpp v128, v143, v146 wave_ror:1 row_mask:0xf bank_mask:0xf
  v_add_f32_dpp v132, v147, v150 wave_ror:1 row_mask:0xf bank_mask:0xf
  v_add_f32_dpp v136, v151, v154 wave_ror:1 row_mask:0xf bank_mask:0xf
  ds_read_b64_tr_b16 v[24:25], v13 offset:5408
  ds_read_b64_tr_b16 v[26:27], v13 offset:5376
  s_waitcnt lgkmcnt(8)
  v_mfma_f32_32x32x16_bf16 v[160:175], v[32:35], v[16:19], v[160:175]
  v_add_f32_dpp v140, v155, v158 wave_ror:1 row_mask:0xf bank_mask:0xf
  v_add_f32_dpp v128, v147, v146 wave_shr:1 row_mask:0xf bank_mask:0xf
  v_add_f32_dpp v132, v151, v150 wave_shr:1 row_mask:0xf bank_mask:0xf
  v_mfma_f32_32x32x16_bf16 v[176:191], v[36:39], v[16:19], v[176:191]
  v_add_f32_dpp v136, v155, v154 wave_shr:1 row_mask:0xf bank_mask:0xf
  v_add_f32_dpp v140, v159, v158 wave_shr:1 row_mask:0xf bank_mask:0xf
  v_add_f32_dpp v129, v124, v145 wave_ror:1 row_mask:0xf bank_mask:0xf
  ds_read_b64_tr_b16 v[28:29], v13 offset:5536
  ds_read_b64_tr_b16 v[30:31], v13 offset:5504
  s_waitcnt lgkmcnt(4)
  v_mfma_f32_32x32x16_bf16 v[160:175], v[48:51], v[20:23], v[160:175]
  v_add_f32_dpp v133, v128, v149 wave_ror:1 row_mask:0xf bank_mask:0xf
  v_add_f32_dpp v137, v132, v153 wave_ror:1 row_mask:0xf bank_mask:0xf
  v_add_f32_dpp v141, v136, v157 wave_ror:1 row_mask:0xf bank_mask:0xf
  v_mfma_f32_32x32x16_bf16 v[176:191], v[52:55], v[20:23], v[176:191]
  v_add_f32_dpp v129, v128, v145 wave_shr:1 row_mask:0xf bank_mask:0xf
  v_add_f32_dpp v133, v132, v149 wave_shr:1 row_mask:0xf bank_mask:0xf
  v_add_f32_dpp v137, v136, v153 wave_shr:1 row_mask:0xf bank_mask:0xf
  ds_read_b64_tr_b16 v[16:17], v13 offset:5664
  ds_read_b64_tr_b16 v[18:19], v13 offset:5632
  s_waitcnt lgkmcnt(4)
  v_mfma_f32_32x32x16_bf16 v[160:175], v[64:67], v[24:27], v[160:175]
  v_add_f32_dpp v141, v140, v157 wave_shr:1 row_mask:0xf bank_mask:0xf
  v_add_f32_dpp v130, v125, v144 wave_ror:1 row_mask:0xf bank_mask:0xf
  v_add_f32_dpp v134, v129, v148 wave_ror:1 row_mask:0xf bank_mask:0xf
  v_mfma_f32_32x32x16_bf16 v[176:191], v[68:71], v[24:27], v[176:191]
  v_add_f32_dpp v138, v133, v152 wave_ror:1 row_mask:0xf bank_mask:0xf
  v_add_f32_dpp v142, v137, v156 wave_ror:1 row_mask:0xf bank_mask:0xf
  v_add_f32_dpp v130, v129, v144 wave_shr:1 row_mask:0xf bank_mask:0xf
  ds_read_b64_tr_b16 v[20:21], v13 offset:5792
  ds_read_b64_tr_b16 v[22:23], v13 offset:5760
  s_waitcnt lgkmcnt(4)
  v_mfma_f32_32x32x16_bf16 v[160:175], v[80:83], v[28:31], v[160:175]
  v_add_f32_dpp v134, v133, v148 wave_shr:1 row_mask:0xf bank_mask:0xf
  v_add_f32_dpp v138, v137, v152 wave_shr:1 row_mask:0xf bank_mask:0xf
  v_add_f32_dpp v142, v141, v156 wave_shr:1 row_mask:0xf bank_mask:0xf
  v_mfma_f32_32x32x16_bf16 v[176:191], v[84:87], v[28:31], v[176:191]
  v_cvt_pk_bf16_f32 v110, v130, v134
  v_cvt_pk_bf16_f32 v111, v138, v142
  ds_write_b16 v14, v110 offset:512
  ds_read_b64_tr_b16 v[24:25], v13 offset:5920
  ds_read_b64_tr_b16 v[26:27], v13 offset:5888
  s_waitcnt lgkmcnt(5)
  v_mfma_f32_32x32x16_bf16 v[176:191], v[32:35], v[16:19], v[176:191]
  ds_write_b16_d16_hi v14, v110 offset:640
  ds_write_b16 v14, v111 offset:768
  ds_write_b16_d16_hi v14, v111 offset:896
  ds_read_b64_tr_b16 v[28:29], v13 offset:6048
  ds_read_b64_tr_b16 v[30:31], v13 offset:6016
  s_waitcnt lgkmcnt(8)
  v_mfma_f32_32x32x16_bf16 v[176:191], v[48:51], v[20:23], v[176:191]
  v_add_f32_dpp v144, v159, v162 wave_ror:1 row_mask:0xf bank_mask:0xf
  v_add_f32_dpp v148, v163, v166 wave_ror:1 row_mask:0xf bank_mask:0xf
  v_add_f32_dpp v152, v167, v170 wave_ror:1 row_mask:0xf bank_mask:0xf
  ds_read_b64_tr_b16 v[16:17], v13 offset:4128
  ds_read_b64_tr_b16 v[18:19], v13 offset:4096
  s_waitcnt lgkmcnt(7)
  v_mfma_f32_32x32x16_bf16 v[176:191], v[64:67], v[24:27], v[176:191]
  v_add_f32_dpp v156, v171, v174 wave_ror:1 row_mask:0xf bank_mask:0xf
  v_add_f32_dpp v144, v163, v162 wave_shr:1 row_mask:0xf bank_mask:0xf
  v_add_f32_dpp v148, v167, v166 wave_shr:1 row_mask:0xf bank_mask:0xf
  ds_read_b64_tr_b16 v[20:21], v13 offset:4256
  ds_read_b64_tr_b16 v[22:23], v13 offset:4224
  ds_read_b128 v[96:99], v10 offset:10688
  ds_read_b128 v[100:103], v10 offset:11200
  ds_read_b128 v[44:47], v10 offset:11712
  ds_read_b128 v[60:63], v10 offset:12224
  s_waitcnt lgkmcnt(8)
  v_mfma_f32_32x32x16_bf16 v[176:191], v[80:83], v[28:31], v[176:191]
  v_add_f32_dpp v152, v171, v170 wave_shr:1 row_mask:0xf bank_mask:0xf
  v_add_f32_dpp v156, v175, v174 wave_shr:1 row_mask:0xf bank_mask:0xf
  v_add_f32_dpp v145, v140, v161 wave_ror:1 row_mask:0xf bank_mask:0xf
  ds_read_b64_tr_b16 v[24:25], v13 offset:4384
  ds_read_b64_tr_b16 v[26:27], v13 offset:4352
  ds_read_b128 v[76:79], v10 offset:10560
  ds_read_b128 v[92:95], v10 offset:11072
  ds_read_b128 v[40:43], v10 offset:11584
  ds_read_b128 v[56:59], v10 offset:12096
  s_waitcnt lgkmcnt(6)
  v_mfma_f32_32x32x16_bf16 v[192:207], v[96:99], v[16:19], 0
  v_add_f32_dpp v149, v144, v165 wave_ror:1 row_mask:0xf bank_mask:0xf
  v_add_f32_dpp v153, v148, v169 wave_ror:1 row_mask:0xf bank_mask:0xf
  v_add_f32_dpp v157, v152, v173 wave_ror:1 row_mask:0xf bank_mask:0xf
  v_mfma_f32_32x32x16_bf16 v[208:223], v[100:103], v[16:19], 0
  v_add_f32_dpp v145, v144, v161 wave_shr:1 row_mask:0xf bank_mask:0xf
  v_add_f32_dpp v149, v148, v165 wave_shr:1 row_mask:0xf bank_mask:0xf
  v_add_f32_dpp v153, v152, v169 wave_shr:1 row_mask:0xf bank_mask:0xf
  v_mfma_f32_32x32x16_bf16 v[224:239], v[44:47], v[16:19], 0
  v_add_f32_dpp v157, v156, v173 wave_shr:1 row_mask:0xf bank_mask:0xf
  v_add_f32_dpp v146, v141, v160 wave_ror:1 row_mask:0xf bank_mask:0xf
  v_add_f32_dpp v150, v145, v164 wave_ror:1 row_mask:0xf bank_mask:0xf
  v_mfma_f32_32x32x16_bf16 v[240:255], v[60:63], v[16:19], 0
  v_add_f32_dpp v154, v149, v168 wave_ror:1 row_mask:0xf bank_mask:0xf
  v_add_f32_dpp v158, v153, v172 wave_ror:1 row_mask:0xf bank_mask:0xf
  v_add_f32_dpp v146, v145, v160 wave_shr:1 row_mask:0xf bank_mask:0xf
  ds_read_b64_tr_b16 v[28:29], v13 offset:4512
  ds_read_b64_tr_b16 v[30:31], v13 offset:4480
  ds_read_b128 v[72:75], v10 offset:10432
  ds_read_b128 v[88:91], v10 offset:10944
  ds_read_b128 v[36:39], v10 offset:11456
  ds_read_b128 v[52:55], v10 offset:11968
  s_waitcnt lgkmcnt(6)
  v_mfma_f32_32x32x16_bf16 v[192:207], v[76:79], v[20:23], v[192:207]
  v_add_f32_dpp v150, v149, v164 wave_shr:1 row_mask:0xf bank_mask:0xf
  v_add_f32_dpp v154, v153, v168 wave_shr:1 row_mask:0xf bank_mask:0xf
  v_add_f32_dpp v158, v157, v172 wave_shr:1 row_mask:0xf bank_mask:0xf
  v_mfma_f32_32x32x16_bf16 v[208:223], v[92:95], v[20:23], v[208:223]
  v_cvt_pk_bf16_f32 v108, v146, v150
  v_cvt_pk_bf16_f32 v109, v154, v158
  ds_write_b16 v14, v108 offset:1024
  v_mfma_f32_32x32x16_bf16 v[224:239], v[40:43], v[20:23], v[224:239]
  ds_write_b16_d16_hi v14, v108 offset:1152
  ds_write_b16 v14, v109 offset:1280
  ds_write_b16_d16_hi v14, v109 offset:1408
  v_mfma_f32_32x32x16_bf16 v[240:255], v[56:59], v[20:23], v[240:255]
  v_add_f32_dpp v160, v175, v178 wave_ror:1 row_mask:0xf bank_mask:0xf
  v_add_f32_dpp v164, v179, v182 wave_ror:1 row_mask:0xf bank_mask:0xf
  v_add_f32_dpp v168, v183, v186 wave_ror:1 row_mask:0xf bank_mask:0xf
  ds_read_b64_tr_b16 v[16:17], v13 offset:4640
  ds_read_b64_tr_b16 v[18:19], v13 offset:4608
  ds_read_b128 v[68:71], v10 offset:10304
  ds_read_b128 v[84:87], v10 offset:10816
  ds_read_b128 v[32:35], v10 offset:11328
  ds_read_b128 v[48:51], v10 offset:11840
  s_waitcnt lgkmcnt(10)
  v_mfma_f32_32x32x16_bf16 v[192:207], v[72:75], v[24:27], v[192:207]
  v_add_f32_dpp v172, v187, v190 wave_ror:1 row_mask:0xf bank_mask:0xf
  v_add_f32_dpp v160, v179, v178 wave_shr:1 row_mask:0xf bank_mask:0xf
  v_add_f32_dpp v164, v183, v182 wave_shr:1 row_mask:0xf bank_mask:0xf
  v_mfma_f32_32x32x16_bf16 v[208:223], v[88:91], v[24:27], v[208:223]
  v_add_f32_dpp v168, v187, v186 wave_shr:1 row_mask:0xf bank_mask:0xf
  v_add_f32_dpp v172, v191, v190 wave_shr:1 row_mask:0xf bank_mask:0xf
  v_add_f32_dpp v161, v156, v177 wave_ror:1 row_mask:0xf bank_mask:0xf
  v_mfma_f32_32x32x16_bf16 v[224:239], v[36:39], v[24:27], v[224:239]
  v_add_f32_dpp v165, v160, v181 wave_ror:1 row_mask:0xf bank_mask:0xf
  v_add_f32_dpp v169, v164, v185 wave_ror:1 row_mask:0xf bank_mask:0xf
  v_add_f32_dpp v173, v168, v189 wave_ror:1 row_mask:0xf bank_mask:0xf
  v_mfma_f32_32x32x16_bf16 v[240:255], v[52:55], v[24:27], v[240:255]
  v_add_f32_dpp v161, v160, v177 wave_shr:1 row_mask:0xf bank_mask:0xf
  v_add_f32_dpp v165, v164, v181 wave_shr:1 row_mask:0xf bank_mask:0xf
  v_add_f32_dpp v169, v168, v185 wave_shr:1 row_mask:0xf bank_mask:0xf
  ds_read_b64_tr_b16 v[20:21], v13 offset:4768
  ds_read_b64_tr_b16 v[22:23], v13 offset:4736
  ds_read_b128 v[64:67], v10 offset:10176
  s_waitcnt lgkmcnt(3)
  v_mfma_f32_32x32x16_bf16 v[192:207], v[68:71], v[28:31], v[192:207]
  v_add_f32_dpp v173, v172, v189 wave_shr:1 row_mask:0xf bank_mask:0xf
  v_add_f32_dpp v162, v157, v176 wave_ror:1 row_mask:0xf bank_mask:0xf
  v_add_f32_dpp v166, v161, v180 wave_ror:1 row_mask:0xf bank_mask:0xf
  v_mfma_f32_32x32x16_bf16 v[208:223], v[84:87], v[28:31], v[208:223]
  v_add_f32_dpp v170, v165, v184 wave_ror:1 row_mask:0xf bank_mask:0xf
  v_add_f32_dpp v174, v169, v188 wave_ror:1 row_mask:0xf bank_mask:0xf
  v_add_f32_dpp v162, v161, v176 wave_shr:1 row_mask:0xf bank_mask:0xf
  v_mfma_f32_32x32x16_bf16 v[224:239], v[32:35], v[28:31], v[224:239]
  v_add_f32_dpp v166, v165, v180 wave_shr:1 row_mask:0xf bank_mask:0xf
  v_add_f32_dpp v170, v169, v184 wave_shr:1 row_mask:0xf bank_mask:0xf
  v_add_f32_dpp v174, v173, v188 wave_shr:1 row_mask:0xf bank_mask:0xf
  v_mfma_f32_32x32x16_bf16 v[240:255], v[48:51], v[28:31], v[240:255]
  v_cvt_pk_bf16_f32 v110, v162, v166
  v_cvt_pk_bf16_f32 v111, v170, v174
  ds_write_b16 v14, v110 offset:1536
  ds_read_b64_tr_b16 v[24:25], v13 offset:4896
  ds_read_b64_tr_b16 v[26:27], v13 offset:4864
  ds_read_b128 v[80:83], v10 offset:10048
  ds_read_b128 v[60:63], v10 offset:9920
  s_waitcnt lgkmcnt(5)
  v_mfma_f32_32x32x16_bf16 v[192:207], v[64:67], v[16:19], v[192:207]
  ds_write_b16_d16_hi v14, v110 offset:1664
  ds_write_b16 v14, v111 offset:1792
  ds_write_b16_d16_hi v14, v111 offset:1920
  v_mfma_f32_32x32x16_bf16 v[208:223], v[96:99], v[16:19], v[208:223]
  v_mfma_f32_32x32x16_bf16 v[224:239], v[100:103], v[16:19], v[224:239]
  v_mfma_f32_32x32x16_bf16 v[240:255], v[44:47], v[16:19], v[240:255]
  ds_read_b64_tr_b16 v[28:29], v13 offset:5024
  ds_read_b64_tr_b16 v[30:31], v13 offset:4992
  ds_read_b128 v[56:59], v10 offset:9792
  s_waitcnt lgkmcnt(7)
  v_mfma_f32_32x32x16_bf16 v[192:207], v[80:83], v[20:23], v[192:207]
  v_mfma_f32_32x32x16_bf16 v[208:223], v[76:79], v[20:23], v[208:223]
  v_mfma_f32_32x32x16_bf16 v[224:239], v[92:95], v[20:23], v[224:239]
  v_mfma_f32_32x32x16_bf16 v[240:255], v[40:43], v[20:23], v[240:255]
  ds_read_b64_tr_b16 v[16:17], v13 offset:5152
  ds_read_b64_tr_b16 v[18:19], v13 offset:5120
  ds_read_b128 v[52:55], v10 offset:9664
  s_waitcnt lgkmcnt(9)
  v_mfma_f32_32x32x16_bf16 v[192:207], v[60:63], v[24:27], v[192:207]
  v_mfma_f32_32x32x16_bf16 v[208:223], v[72:75], v[24:27], v[208:223]
  v_mfma_f32_32x32x16_bf16 v[224:239], v[88:91], v[24:27], v[224:239]
  v_mfma_f32_32x32x16_bf16 v[240:255], v[36:39], v[24:27], v[240:255]
  ds_read_b64_tr_b16 v[20:21], v13 offset:5280
  ds_read_b64_tr_b16 v[22:23], v13 offset:5248
  ds_read_b128 v[48:51], v10 offset:9536
  s_waitcnt lgkmcnt(6)
  v_mfma_f32_32x32x16_bf16 v[192:207], v[56:59], v[28:31], v[192:207]
  v_mfma_f32_32x32x16_bf16 v[208:223], v[68:71], v[28:31], v[208:223]
  v_mfma_f32_32x32x16_bf16 v[224:239], v[84:87], v[28:31], v[224:239]
  v_mfma_f32_32x32x16_bf16 v[240:255], v[32:35], v[28:31], v[240:255]
  ds_read_b64_tr_b16 v[24:25], v13 offset:5408
  ds_read_b64_tr_b16 v[26:27], v13 offset:5376
  ds_read_b128 v[44:47], v10 offset:9408
  s_waitcnt lgkmcnt(6)
  v_mfma_f32_32x32x16_bf16 v[192:207], v[52:55], v[16:19], v[192:207]
  v_mfma_f32_32x32x16_bf16 v[208:223], v[64:67], v[16:19], v[208:223]
  v_mfma_f32_32x32x16_bf16 v[224:239], v[96:99], v[16:19], v[224:239]
  v_mfma_f32_32x32x16_bf16 v[240:255], v[100:103], v[16:19], v[240:255]
  ds_read_b64_tr_b16 v[28:29], v13 offset:5536
  ds_read_b64_tr_b16 v[30:31], v13 offset:5504
  ds_read_b128 v[40:43], v10 offset:9280
  s_waitcnt lgkmcnt(6)
  v_mfma_f32_32x32x16_bf16 v[192:207], v[48:51], v[20:23], v[192:207]
  v_mfma_f32_32x32x16_bf16 v[208:223], v[80:83], v[20:23], v[208:223]
  v_mfma_f32_32x32x16_bf16 v[224:239], v[76:79], v[20:23], v[224:239]
  v_mfma_f32_32x32x16_bf16 v[240:255], v[92:95], v[20:23], v[240:255]
  ds_read_b64_tr_b16 v[16:17], v13 offset:5664
  ds_read_b64_tr_b16 v[18:19], v13 offset:5632
  ds_read_b128 v[36:39], v10 offset:9152
  s_waitcnt lgkmcnt(6)
  v_mfma_f32_32x32x16_bf16 v[192:207], v[44:47], v[24:27], v[192:207]
  v_mfma_f32_32x32x16_bf16 v[208:223], v[60:63], v[24:27], v[208:223]
  v_mfma_f32_32x32x16_bf16 v[224:239], v[72:75], v[24:27], v[224:239]
  v_mfma_f32_32x32x16_bf16 v[240:255], v[88:91], v[24:27], v[240:255]
  ds_read_b64_tr_b16 v[20:21], v13 offset:5792
  ds_read_b64_tr_b16 v[22:23], v13 offset:5760
  ds_read_b128 v[32:35], v10 offset:9024
  s_waitcnt lgkmcnt(6)
  v_mfma_f32_32x32x16_bf16 v[192:207], v[40:43], v[28:31], v[192:207]
  v_mfma_f32_32x32x16_bf16 v[208:223], v[56:59], v[28:31], v[208:223]
  v_mfma_f32_32x32x16_bf16 v[224:239], v[68:71], v[28:31], v[224:239]
  v_mfma_f32_32x32x16_bf16 v[240:255], v[84:87], v[28:31], v[240:255]
  ds_read_b64_tr_b16 v[24:25], v13 offset:5920
  ds_read_b64_tr_b16 v[26:27], v13 offset:5888
  ds_read_b128 v[100:103], v10 offset:8896
  s_waitcnt lgkmcnt(6)
  v_mfma_f32_32x32x16_bf16 v[192:207], v[36:39], v[16:19], v[192:207]
  v_mfma_f32_32x32x16_bf16 v[208:223], v[52:55], v[16:19], v[208:223]
  v_mfma_f32_32x32x16_bf16 v[224:239], v[64:67], v[16:19], v[224:239]
  v_mfma_f32_32x32x16_bf16 v[240:255], v[96:99], v[16:19], v[240:255]
  ds_read_b64_tr_b16 v[28:29], v13 offset:6048
  ds_read_b64_tr_b16 v[30:31], v13 offset:6016
  ds_read_b128 v[92:95], v10 offset:8768
  s_waitcnt lgkmcnt(6)
  v_mfma_f32_32x32x16_bf16 v[192:207], v[32:35], v[20:23], v[192:207]
  v_mfma_f32_32x32x16_bf16 v[208:223], v[48:51], v[20:23], v[208:223]
  v_mfma_f32_32x32x16_bf16 v[224:239], v[80:83], v[20:23], v[224:239]
  v_mfma_f32_32x32x16_bf16 v[240:255], v[76:79], v[20:23], v[240:255]
  ds_read_b64_tr_b16 v[16:17], v13 offset:6176
  ds_read_b64_tr_b16 v[18:19], v13 offset:6144
  ds_read_b128 v[88:91], v10 offset:8640
  s_waitcnt lgkmcnt(6)
  v_mfma_f32_32x32x16_bf16 v[192:207], v[100:103], v[24:27], v[192:207]
  v_mfma_f32_32x32x16_bf16 v[208:223], v[44:47], v[24:27], v[208:223]
  v_mfma_f32_32x32x16_bf16 v[224:239], v[60:63], v[24:27], v[224:239]
  v_mfma_f32_32x32x16_bf16 v[240:255], v[72:75], v[24:27], v[240:255]
  ds_read_b64_tr_b16 v[20:21], v13 offset:6304
  ds_read_b64_tr_b16 v[22:23], v13 offset:6272
  ds_read_b128 v[84:87], v10 offset:8512
  s_waitcnt lgkmcnt(6)
  v_mfma_f32_32x32x16_bf16 v[192:207], v[92:95], v[28:31], v[192:207]
  v_mfma_f32_32x32x16_bf16 v[208:223], v[40:43], v[28:31], v[208:223]
  v_mfma_f32_32x32x16_bf16 v[224:239], v[56:59], v[28:31], v[224:239]
  v_mfma_f32_32x32x16_bf16 v[240:255], v[68:71], v[28:31], v[240:255]
  ds_read_b64_tr_b16 v[24:25], v13 offset:6432
  ds_read_b64_tr_b16 v[26:27], v13 offset:6400
  ds_read_b128 v[96:99], v10 offset:8384
  s_waitcnt lgkmcnt(6)
  v_mfma_f32_32x32x16_bf16 v[192:207], v[88:91], v[16:19], v[192:207]
  v_mfma_f32_32x32x16_bf16 v[208:223], v[36:39], v[16:19], v[208:223]
  v_mfma_f32_32x32x16_bf16 v[224:239], v[52:55], v[16:19], v[224:239]
  v_mfma_f32_32x32x16_bf16 v[240:255], v[64:67], v[16:19], v[240:255]
  ds_read_b64_tr_b16 v[28:29], v13 offset:6560
  ds_read_b64_tr_b16 v[30:31], v13 offset:6528
  ds_read_b128 v[76:79], v10 offset:8256
  s_waitcnt lgkmcnt(6)
  v_mfma_f32_32x32x16_bf16 v[192:207], v[84:87], v[20:23], v[192:207]
  v_mfma_f32_32x32x16_bf16 v[208:223], v[32:35], v[20:23], v[208:223]
  v_mfma_f32_32x32x16_bf16 v[224:239], v[48:51], v[20:23], v[224:239]
  v_mfma_f32_32x32x16_bf16 v[240:255], v[80:83], v[20:23], v[240:255]
  ds_read_b64_tr_b16 v[16:17], v13 offset:6688
  ds_read_b64_tr_b16 v[18:19], v13 offset:6656
  s_waitcnt lgkmcnt(5)
  v_mfma_f32_32x32x16_bf16 v[192:207], v[96:99], v[24:27], v[192:207]
  v_mfma_f32_32x32x16_bf16 v[208:223], v[100:103], v[24:27], v[208:223]
  v_mfma_f32_32x32x16_bf16 v[224:239], v[44:47], v[24:27], v[224:239]
  v_mfma_f32_32x32x16_bf16 v[240:255], v[60:63], v[24:27], v[240:255]
  ds_read_b64_tr_b16 v[20:21], v13 offset:6816
  ds_read_b64_tr_b16 v[22:23], v13 offset:6784
  s_waitcnt lgkmcnt(4)
  v_mfma_f32_32x32x16_bf16 v[192:207], v[76:79], v[28:31], v[192:207]
  v_mfma_f32_32x32x16_bf16 v[208:223], v[92:95], v[28:31], v[208:223]
  v_mfma_f32_32x32x16_bf16 v[224:239], v[40:43], v[28:31], v[224:239]
  s_nop 9
  v_add_f32_dpp v176, v191, v194 wave_ror:1 row_mask:0xf bank_mask:0xf
  v_add_f32_dpp v180, v195, v198 wave_ror:1 row_mask:0xf bank_mask:0xf
  v_add_f32_dpp v184, v199, v202 wave_ror:1 row_mask:0xf bank_mask:0xf
  v_mfma_f32_32x32x16_bf16 v[240:255], v[56:59], v[28:31], v[240:255]
  v_add_f32_dpp v188, v203, v206 wave_ror:1 row_mask:0xf bank_mask:0xf
  v_add_f32_dpp v176, v195, v194 wave_shr:1 row_mask:0xf bank_mask:0xf
  v_add_f32_dpp v180, v199, v198 wave_shr:1 row_mask:0xf bank_mask:0xf
  ds_read_b64_tr_b16 v[24:25], v13 offset:6944
  ds_read_b64_tr_b16 v[26:27], v13 offset:6912
  s_waitcnt lgkmcnt(4)
  v_mfma_f32_32x32x16_bf16 v[208:223], v[88:91], v[16:19], v[208:223]
  v_add_f32_dpp v184, v203, v202 wave_shr:1 row_mask:0xf bank_mask:0xf
  v_add_f32_dpp v188, v207, v206 wave_shr:1 row_mask:0xf bank_mask:0xf
  v_add_f32_dpp v177, v172, v193 wave_ror:1 row_mask:0xf bank_mask:0xf
  v_mfma_f32_32x32x16_bf16 v[224:239], v[36:39], v[16:19], v[224:239]
  v_add_f32_dpp v181, v176, v197 wave_ror:1 row_mask:0xf bank_mask:0xf
  v_add_f32_dpp v185, v180, v201 wave_ror:1 row_mask:0xf bank_mask:0xf
  v_add_f32_dpp v189, v184, v205 wave_ror:1 row_mask:0xf bank_mask:0xf
  v_mfma_f32_32x32x16_bf16 v[240:255], v[52:55], v[16:19], v[240:255]
  v_add_f32_dpp v177, v176, v193 wave_shr:1 row_mask:0xf bank_mask:0xf
  v_add_f32_dpp v181, v180, v197 wave_shr:1 row_mask:0xf bank_mask:0xf
  v_add_f32_dpp v185, v184, v201 wave_shr:1 row_mask:0xf bank_mask:0xf
  ds_read_b64_tr_b16 v[28:29], v13 offset:7072
  ds_read_b64_tr_b16 v[30:31], v13 offset:7040
  s_waitcnt lgkmcnt(4)
  v_mfma_f32_32x32x16_bf16 v[208:223], v[84:87], v[20:23], v[208:223]
  v_add_f32_dpp v189, v188, v205 wave_shr:1 row_mask:0xf bank_mask:0xf
  v_add_f32_dpp v178, v173, v192 wave_ror:1 row_mask:0xf bank_mask:0xf
  v_add_f32_dpp v182, v177, v196 wave_ror:1 row_mask:0xf bank_mask:0xf
  v_mfma_f32_32x32x16_bf16 v[224:239], v[32:35], v[20:23], v[224:239]
  v_add_f32_dpp v186, v181, v200 wave_ror:1 row_mask:0xf bank_mask:0xf
  v_add_f32_dpp v190, v185, v204 wave_ror:1 row_mask:0xf bank_mask:0xf
  v_add_f32_dpp v178, v177, v192 wave_shr:1 row_mask:0xf bank_mask:0xf
  v_mfma_f32_32x32x16_bf16 v[240:255], v[48:51], v[20:23], v[240:255]
  v_add_f32_dpp v182, v181, v196 wave_shr:1 row_mask:0xf bank_mask:0xf
  v_add_f32_dpp v186, v185, v200 wave_shr:1 row_mask:0xf bank_mask:0xf
  v_add_f32_dpp v190, v189, v204 wave_shr:1 row_mask:0xf bank_mask:0xf
  ds_read_b64_tr_b16 v[16:17], v13 offset:7200
  ds_read_b64_tr_b16 v[18:19], v13 offset:7168
  s_waitcnt lgkmcnt(4)
  v_mfma_f32_32x32x16_bf16 v[208:223], v[96:99], v[24:27], v[208:223]
  v_cvt_pk_bf16_f32 v108, v178, v182
  v_cvt_pk_bf16_f32 v109, v186, v190
  ds_write_b16 v14, v108 offset:2048
  v_mfma_f32_32x32x16_bf16 v[224:239], v[100:103], v[24:27], v[224:239]
  ds_write_b16_d16_hi v14, v108 offset:2176
  ds_write_b16 v14, v109 offset:2304
  ds_write_b16_d16_hi v14, v109 offset:2432
  v_mfma_f32_32x32x16_bf16 v[240:255], v[44:47], v[24:27], v[240:255]
  ds_read_b64_tr_b16 v[20:21], v13 offset:7328
  ds_read_b64_tr_b16 v[22:23], v13 offset:7296
  s_waitcnt lgkmcnt(8)
  v_mfma_f32_32x32x16_bf16 v[208:223], v[76:79], v[28:31], v[208:223]
  v_mfma_f32_32x32x16_bf16 v[224:239], v[92:95], v[28:31], v[224:239]
  v_mfma_f32_32x32x16_bf16 v[240:255], v[40:43], v[28:31], v[240:255]
  s_nop 9
  v_add_f32_dpp v192, v207, v210 wave_ror:1 row_mask:0xf bank_mask:0xf
  v_add_f32_dpp v196, v211, v214 wave_ror:1 row_mask:0xf bank_mask:0xf
  v_add_f32_dpp v200, v215, v218 wave_ror:1 row_mask:0xf bank_mask:0xf
  ds_read_b64_tr_b16 v[24:25], v13 offset:7456
  ds_read_b64_tr_b16 v[26:27], v13 offset:7424
  s_waitcnt lgkmcnt(8)
  v_mfma_f32_32x32x16_bf16 v[224:239], v[88:91], v[16:19], v[224:239]
  v_add_f32_dpp v204, v219, v222 wave_ror:1 row_mask:0xf bank_mask:0xf
  v_add_f32_dpp v192, v211, v210 wave_shr:1 row_mask:0xf bank_mask:0xf
  v_add_f32_dpp v196, v215, v214 wave_shr:1 row_mask:0xf bank_mask:0xf
  v_mfma_f32_32x32x16_bf16 v[240:255], v[36:39], v[16:19], v[240:255]
  v_add_f32_dpp v200, v219, v218 wave_shr:1 row_mask:0xf bank_mask:0xf
  v_add_f32_dpp v204, v223, v222 wave_shr:1 row_mask:0xf bank_mask:0xf
  v_add_f32_dpp v193, v188, v209 wave_ror:1 row_mask:0xf bank_mask:0xf
  ds_read_b64_tr_b16 v[28:29], v13 offset:7584
  ds_read_b64_tr_b16 v[30:31], v13 offset:7552
  s_waitcnt lgkmcnt(4)
  v_mfma_f32_32x32x16_bf16 v[224:239], v[84:87], v[20:23], v[224:239]
  v_add_f32_dpp v197, v192, v213 wave_ror:1 row_mask:0xf bank_mask:0xf
  v_add_f32_dpp v201, v196, v217 wave_ror:1 row_mask:0xf bank_mask:0xf
  v_add_f32_dpp v205, v200, v221 wave_ror:1 row_mask:0xf bank_mask:0xf
  v_mfma_f32_32x32x16_bf16 v[240:255], v[32:35], v[20:23], v[240:255]
  v_add_f32_dpp v193, v192, v209 wave_shr:1 row_mask:0xf bank_mask:0xf
  v_add_f32_dpp v197, v196, v213 wave_shr:1 row_mask:0xf bank_mask:0xf
  v_add_f32_dpp v201, v200, v217 wave_shr:1 row_mask:0xf bank_mask:0xf
  ds_read_b64_tr_b16 v[16:17], v13 offset:7712
  ds_read_b64_tr_b16 v[18:19], v13 offset:7680
  s_waitcnt lgkmcnt(4)
  v_mfma_f32_32x32x16_bf16 v[224:239], v[96:99], v[24:27], v[224:239]
  v_add_f32_dpp v205, v204, v221 wave_shr:1 row_mask:0xf bank_mask:0xf
  v_add_f32_dpp v194, v189, v208 wave_ror:1 row_mask:0xf bank_mask:0xf
  v_add_f32_dpp v198, v193, v212 wave_ror:1 row_mask:0xf bank_mask:0xf
  v_mfma_f32_32x32x16_bf16 v[240:255], v[100:103], v[24:27], v[240:255]
  v_add_f32_dpp v202, v197, v216 wave_ror:1 row_mask:0xf bank_mask:0xf
  v_add_f32_dpp v206, v201, v220 wave_ror:1 row_mask:0xf bank_mask:0xf
  v_add_f32_dpp v194, v193, v208 wave_shr:1 row_mask:0xf bank_mask:0xf
  ds_read_b64_tr_b16 v[20:21], v13 offset:7840
  ds_read_b64_tr_b16 v[22:23], v13 offset:7808
  s_waitcnt lgkmcnt(4)
  v_mfma_f32_32x32x16_bf16 v[224:239], v[76:79], v[28:31], v[224:239]
  v_add_f32_dpp v198, v197, v212 wave_shr:1 row_mask:0xf bank_mask:0xf
  v_add_f32_dpp v202, v201, v216 wave_shr:1 row_mask:0xf bank_mask:0xf
  v_add_f32_dpp v206, v205, v220 wave_shr:1 row_mask:0xf bank_mask:0xf
  v_mfma_f32_32x32x16_bf16 v[240:255], v[92:95], v[28:31], v[240:255]
  v_cvt_pk_bf16_f32 v110, v194, v198
  v_cvt_pk_bf16_f32 v111, v202, v206
  ds_write_b16 v14, v110 offset:2560
  ds_read_b64_tr_b16 v[24:25], v13 offset:7968
  ds_read_b64_tr_b16 v[26:27], v13 offset:7936
  s_waitcnt lgkmcnt(5)
  v_mfma_f32_32x32x16_bf16 v[240:255], v[88:91], v[16:19], v[240:255]
  ds_write_b16_d16_hi v14, v110 offset:2688
  ds_write_b16 v14, v111 offset:2816
  ds_write_b16_d16_hi v14, v111 offset:2944
  ds_read_b64_tr_b16 v[28:29], v13 offset:8096
  ds_read_b64_tr_b16 v[30:31], v13 offset:8064
  s_waitcnt lgkmcnt(8)
  v_mfma_f32_32x32x16_bf16 v[240:255], v[84:87], v[20:23], v[240:255]
  v_add_f32_dpp v208, v223, v226 wave_ror:1 row_mask:0xf bank_mask:0xf
  v_add_f32_dpp v212, v227, v230 wave_ror:1 row_mask:0xf bank_mask:0xf
  v_add_f32_dpp v216, v231, v234 wave_ror:1 row_mask:0xf bank_mask:0xf
  s_waitcnt lgkmcnt(5)
  v_mfma_f32_32x32x16_bf16 v[240:255], v[96:99], v[24:27], v[240:255]
  v_add_f32_dpp v220, v235, v238 wave_ror:1 row_mask:0xf bank_mask:0xf
  v_add_f32_dpp v208, v227, v226 wave_shr:1 row_mask:0xf bank_mask:0xf
  v_add_f32_dpp v212, v231, v230 wave_shr:1 row_mask:0xf bank_mask:0xf
  s_waitcnt lgkmcnt(0)
  v_mfma_f32_32x32x16_bf16 v[240:255], v[76:79], v[28:31], v[240:255]
  v_add_f32_dpp v216, v235, v234 wave_shr:1 row_mask:0xf bank_mask:0xf
  v_add_f32_dpp v220, v239, v238 wave_shr:1 row_mask:0xf bank_mask:0xf
  v_add_f32_dpp v209, v204, v225 wave_ror:1 row_mask:0xf bank_mask:0xf
  s_setprio 3
  v_add_f32_dpp v213, v208, v229 wave_ror:1 row_mask:0xf bank_mask:0xf
  v_add_f32_dpp v217, v212, v233 wave_ror:1 row_mask:0xf bank_mask:0xf
  v_add_f32_dpp v221, v216, v237 wave_ror:1 row_mask:0xf bank_mask:0xf
  v_add_f32_dpp v209, v208, v225 wave_shr:1 row_mask:0xf bank_mask:0xf
  v_add_f32_dpp v213, v212, v229 wave_shr:1 row_mask:0xf bank_mask:0xf
  v_add_f32_dpp v217, v216, v233 wave_shr:1 row_mask:0xf bank_mask:0xf
  v_add_f32_dpp v221, v220, v237 wave_shr:1 row_mask:0xf bank_mask:0xf
  v_add_f32_dpp v210, v205, v224 wave_ror:1 row_mask:0xf bank_mask:0xf
  v_add_f32_dpp v214, v209, v228 wave_ror:1 row_mask:0xf bank_mask:0xf
  v_add_f32_dpp v218, v213, v232 wave_ror:1 row_mask:0xf bank_mask:0xf
  v_add_f32_dpp v222, v217, v236 wave_ror:1 row_mask:0xf bank_mask:0xf
  v_add_f32_dpp v210, v209, v224 wave_shr:1 row_mask:0xf bank_mask:0xf
  v_add_f32_dpp v214, v213, v228 wave_shr:1 row_mask:0xf bank_mask:0xf
  v_add_f32_dpp v218, v217, v232 wave_shr:1 row_mask:0xf bank_mask:0xf
  v_add_f32_dpp v222, v221, v236 wave_shr:1 row_mask:0xf bank_mask:0xf
  v_cvt_pk_bf16_f32 v108, v210, v214
  v_cvt_pk_bf16_f32 v109, v218, v222
  ds_write_b16 v14, v108 offset:3072
  ds_write_b16_d16_hi v14, v108 offset:3200
  ds_write_b16 v14, v109 offset:3328
  ds_write_b16_d16_hi v14, v109 offset:3456
  v_add_f32_dpp v224, v239, v242 wave_ror:1 row_mask:0xf bank_mask:0xf
  v_add_f32_dpp v228, v243, v246 wave_ror:1 row_mask:0xf bank_mask:0xf
  v_add_f32_dpp v232, v247, v250 wave_ror:1 row_mask:0xf bank_mask:0xf
  v_add_f32_dpp v236, v251, v254 wave_ror:1 row_mask:0xf bank_mask:0xf
  v_add_f32_dpp v224, v243, v242 wave_shr:1 row_mask:0xf bank_mask:0xf
  v_add_f32_dpp v228, v247, v246 wave_shr:1 row_mask:0xf bank_mask:0xf
  v_add_f32_dpp v232, v251, v250 wave_shr:1 row_mask:0xf bank_mask:0xf
  v_add_f32_dpp v236, v255, v254 wave_shr:1 row_mask:0xf bank_mask:0xf
  v_add_f32_dpp v225, v220, v241 wave_ror:1 row_mask:0xf bank_mask:0xf
  v_add_f32_dpp v229, v224, v245 wave_ror:1 row_mask:0xf bank_mask:0xf
  v_add_f32_dpp v233, v228, v249 wave_ror:1 row_mask:0xf bank_mask:0xf
  v_add_f32_dpp v237, v232, v253 wave_ror:1 row_mask:0xf bank_mask:0xf
  v_add_f32_dpp v225, v224, v241 wave_shr:1 row_mask:0xf bank_mask:0xf
  v_add_f32_dpp v229, v228, v245 wave_shr:1 row_mask:0xf bank_mask:0xf
  v_add_f32_dpp v233, v232, v249 wave_shr:1 row_mask:0xf bank_mask:0xf
  v_add_f32_dpp v237, v236, v253 wave_shr:1 row_mask:0xf bank_mask:0xf
  v_add_f32_dpp v226, v221, v240 wave_ror:1 row_mask:0xf bank_mask:0xf
  v_add_f32_dpp v230, v225, v244 wave_ror:1 row_mask:0xf bank_mask:0xf
  v_add_f32_dpp v234, v229, v248 wave_ror:1 row_mask:0xf bank_mask:0xf
  v_add_f32_dpp v238, v233, v252 wave_ror:1 row_mask:0xf bank_mask:0xf
  v_add_f32_dpp v226, v225, v240 wave_shr:1 row_mask:0xf bank_mask:0xf
  v_add_f32_dpp v230, v229, v244 wave_shr:1 row_mask:0xf bank_mask:0xf
  v_add_f32_dpp v234, v233, v248 wave_shr:1 row_mask:0xf bank_mask:0xf
  v_add_f32_dpp v238, v237, v252 wave_shr:1 row_mask:0xf bank_mask:0xf
  v_cvt_pk_bf16_f32 v110, v226, v230
  v_cvt_pk_bf16_f32 v111, v234, v238
  ds_write_b16 v14, v110 offset:3584
  ds_write_b16_d16_hi v14, v110 offset:3712
  ds_write_b16 v14, v111 offset:3840
  ds_write_b16_d16_hi v14, v111 offset:3968
  s_lshl_b32 s7, s5, 12
  ds_read_b128 v[16:19], v12 offset:0
  ds_read_b128 v[20:23], v12 offset:1024
  ds_read_b128 v[24:27], v12 offset:2048
  ds_read_b128 v[28:31], v12 offset:3072
  s_waitcnt lgkmcnt(3)
  buffer_store_dwordx4 v[16:19], v4, s[56:59], s7 offen offset:0 sc1
  s_waitcnt lgkmcnt(2)
  buffer_store_dwordx4 v[20:23], v4, s[56:59], s7 offen offset:1024 sc1
  s_waitcnt lgkmcnt(1)
  buffer_store_dwordx4 v[24:27], v4, s[56:59], s7 offen offset:2048 sc1
  s_waitcnt lgkmcnt(0)
  buffer_store_dwordx4 v[28:31], v4, s[56:59], s7 offen offset:3072 sc1
  s_mul_i32 s7, s3, 3277
  s_lshr_b32 s7, s7, 16
  s_mul_i32 s10, s7, 176
  s_lshl_b32 s7, s3, 2
  s_add_u32 s7, s7, s10
  s_add_u32 s12, s46, 21102592
  s_addc_u32 s13, s47, 0
  s_mov_b32 s14, 4096
  s_mov_b32 s15, 0x20000
  s_waitcnt vmcnt(0)
  s_barrier
  v_mov_b32 v14, 0
  v_mov_b32 v15, 1
  v_cmp_eq_u32 vcc, 0, v0
  s_nop 0
  s_and_saveexec_b64 s[8:9], vcc
  s_cbranch_execz sig_14
  buffer_store_dword v15, v14, s[12:15], s7 offen sc1
sig_14:
  s_mov_b64 exec, s[8:9]
  s_endpgm
l2_kernel_r1:
  s_sub_u32 s3, s2, 160
  s_waitcnt lgkmcnt(0)
  s_setprio 1
  s_add_u32 s48, s46, 8388608
  s_addc_u32 s49, s47, 0
  s_mov_b32 s50, 7077888
  s_mov_b32 s51, 0x20000
  s_add_u32 s52, s46, 5242880
  s_addc_u32 s53, s47, 0
  s_mov_b32 s54, 2211840
  s_mov_b32 s55, 0x20000
  s_add_u32 s56, s46, 16777216
  s_addc_u32 s57, s47, 0
  s_mov_b32 s58, 2621440
  s_mov_b32 s59, 0x20000
  s_mov_b32 s60, s16
  s_mov_b32 s61, s17
  s_mov_b32 s62, 2621440
  s_mov_b32 s63, 0x20000
  s_mov_b32 s64, s42
  s_mov_b32 s65, s43
  s_mov_b32 s66, 2621440
  s_mov_b32 s67, 0x20000
  s_and_b32 s4, s3, 7
  s_lshr_b32 s5, s3, 3
  s_and_b32 s6, s4, 3
  s_lshl_b32 s6, s6, 3
  s_and_b32 s7, s5, 7
  s_add_u32 s6, s6, s7
  s_lshr_b32 s7, s4, 2
  s_lshl_b32 s7, s7, 2
  s_lshr_b32 s8, s5, 3
  s_add_u32 s7, s7, s8
  v_and_b32 v2, 63, v0
  v_lshrrev_b32 v3, 6, v0
  s_nop 0
  v_readfirstlane_b32 s8, v3
  v_lshlrev_b32 v4, 4, v2
  v_add_u32 v5, 55296, v4
  v_add_u32 v6, 110592, v4
  v_add_u32 v7, 165888, v4
  v_add_u32 v8, 221184, v4
  s_add_u32 s9, s8, 0
  s_and_b32 s9, s9, 3
  s_mul_i32 s9, s9, 55296
  v_add_u32 v252, s9, v4
  s_add_u32 s9, s8, 1
  s_and_b32 s9, s9, 3
  s_mul_i32 s9, s9, 55296
  v_add_u32 v253, s9, v4
  s_add_u32 s9, s8, 2
  s_and_b32 s9, s9, 3
  s_mul_i32 s9, s9, 55296
  v_add_u32 v254, s9, v4
  s_add_u32 s9, s8, 3
  s_and_b32 s9, s9, 3
  s_mul_i32 s9, s9, 55296
  v_add_u32 v255, s9, v4
  s_mul_i32 s9, s6, 221184
  s_lshl_b32 s10, s8, 10
  s_add_u32 s9, s9, s10
  s_mul_i32 s11, s7, 276480
  s_add_u32 s10, s11, s10
  buffer_load_dwordx4 v[112:115], v4, s[52:55], s10 offen
  buffer_load_dwordx4 v[96:99], v252, s[48:51], s9 offen
  buffer_load_dwordx4 v[116:119], v5, s[52:55], s10 offen
  buffer_load_dwordx4 v[100:103], v253, s[48:51], s9 offen
  buffer_load_dwordx4 v[120:123], v6, s[52:55], s10 offen
  buffer_load_dwordx4 v[104:107], v254, s[48:51], s9 offen
  buffer_load_dwordx4 v[124:127], v7, s[52:55], s10 offen
  buffer_load_dwordx4 v[108:111], v255, s[48:51], s9 offen
  buffer_load_dwordx4 v[128:131], v8, s[52:55], s10 offen
  s_add_u32 s9, s9, 4096
  s_add_u32 s10, s10, 4096
  buffer_load_dwordx4 v[148:151], v4, s[52:55], s10 offen
  buffer_load_dwordx4 v[132:135], v252, s[48:51], s9 offen
  buffer_load_dwordx4 v[152:155], v5, s[52:55], s10 offen
  buffer_load_dwordx4 v[136:139], v253, s[48:51], s9 offen
  buffer_load_dwordx4 v[156:159], v6, s[52:55], s10 offen
  buffer_load_dwordx4 v[140:143], v254, s[48:51], s9 offen
  buffer_load_dwordx4 v[160:163], v7, s[52:55], s10 offen
  buffer_load_dwordx4 v[144:147], v255, s[48:51], s9 offen
  buffer_load_dwordx4 v[164:167], v8, s[52:55], s10 offen
  s_add_u32 s9, s9, 4096
  s_add_u32 s10, s10, 4096
  buffer_load_dwordx4 v[184:187], v4, s[52:55], s10 offen
  buffer_load_dwordx4 v[168:171], v252, s[48:51], s9 offen
  buffer_load_dwordx4 v[188:191], v5, s[52:55], s10 offen
  buffer_load_dwordx4 v[172:175], v253, s[48:51], s9 offen
  buffer_load_dwordx4 v[192:195], v6, s[52:55], s10 offen
  buffer_load_dwordx4 v[176:179], v254, s[48:51], s9 offen
  buffer_load_dwordx4 v[196:199], v7, s[52:55], s10 offen
  buffer_load_dwordx4 v[180:183], v255, s[48:51], s9 offen
  buffer_load_dwordx4 v[200:203], v8, s[52:55], s10 offen
  s_add_u32 s9, s9, 4096
  s_add_u32 s10, s10, 4096
  v_and_b32 v9, 15, v2
  v_lshrrev_b32 v10, 4, v2
  s_lshl_b32 s11, s6, 6
  s_lshl_b32 s12, s8, 4
  s_add_u32 s11, s11, s12
  v_add_u32 v11, s11, v9
  s_mul_i32 s12, s7, 80
  v_lshl_add_u32 v12, v10, 2, s12
  v_mul_u32_u24 v13, 1280, v11
  v_lshl_add_u32 v13, v12, 1, v13
  v_lshrrev_b32 v14, 1, v2
  v_add_u32 v14, s12, v14
  v_lshlrev_b32 v14, 12, v14
  v_and_b32 v15, 1, v2
  v_lshl_add_u32 v14, v15, 4, v14
  s_lshl_b32 s13, s11, 1
  v_add_u32 v14, s13, v14
  v_add_u32 v15, 0x40000, v14
  v_mov_b32 v251, 0x7f000000
  v_cmp_gt_u32 vcc, 32, v2
  s_nop 1
  v_cndmask_b32 v15, v251, v15, vcc
  s_add_u32 s68, s46, 21102592
  s_addc_u32 s69, s47, 0
  s_mov_b32 s70, 4096
  s_mov_b32 s71, 0x20000
  s_lshl_b32 s72, s7, 8
  v_min_u32 v251, 19, v2
  v_lshlrev_b32 v251, 2, v251
  s_waitcnt vmcnt(18)
  v_mfma_f32_16x16x32_bf16 v[16:19], v[112:115], v[96:99], 0
  v_mfma_f32_16x16x32_bf16 v[20:23], v[112:115], v[100:103], 0
  buffer_load_dwordx4 v[220:223], v4, s[52:55], s10 offen
  v_mfma_f32_16x16x32_bf16 v[24:27], v[112:115], v[104:107], 0
  v_mfma_f32_16x16x32_bf16 v[28:31], v[112:115], v[108:111], 0
  buffer_load_dwordx4 v[204:207], v252, s[48:51], s9 offen
  v_mfma_f32_16x16x32_bf16 v[32:35], v[116:119], v[96:99], 0
  v_mfma_f32_16x16x32_bf16 v[36:39], v[116:119], v[100:103], 0
  buffer_load_dwordx4 v[224:227], v5, s[52:55], s10 offen
  v_mfma_f32_16x16x32_bf16 v[40:43], v[116:119], v[104:107], 0
  v_mfma_f32_16x16x32_bf16 v[44:47], v[116:119], v[108:111], 0
  buffer_load_dwordx4 v[208:211], v253, s[48:51], s9 offen
  v_mfma_f32_16x16x32_bf16 v[48:51], v[120:123], v[96:99], 0
  v_mfma_f32_16x16x32_bf16 v[52:55], v[120:123], v[100:103], 0
  buffer_load_dwordx4 v[228:231], v6, s[52:55], s10 offen
  v_mfma_f32_16x16x32_bf16 v[56:59], v[120:123], v[104:107], 0
  v_mfma_f32_16x16x32_bf16 v[60:63], v[120:123], v[108:111], 0
  buffer_load_dwordx4 v[212:215], v254, s[48:51], s9 offen
  v_mfma_f32_16x16x32_bf16 v[64:67], v[124:127], v[96:99], 0
  v_mfma_f32_16x16x32_bf16 v[68:71], v[124:127], v[100:103], 0
  buffer_load_dwordx4 v[232:235], v7, s[52:55], s10 offen
  v_mfma_f32_16x16x32_bf16 v[72:75], v[124:127], v[104:107], 0
  v_mfma_f32_16x16x32_bf16 v[76:79], v[124:127], v[108:111], 0
  buffer_load_dwordx4 v[216:219], v255, s[48:51], s9 offen
  v_mfma_f32_16x16x32_bf16 v[80:83], v[128:131], v[96:99], 0
  v_mfma_f32_16x16x32_bf16 v[84:87], v[128:131], v[100:103], 0
  buffer_load_dwordx4 v[236:239], v8, s[52:55], s10 offen
  s_add_u32 s9, s9, 4096
  s_add_u32 s10, s10, 4096
  v_mfma_f32_16x16x32_bf16 v[88:91], v[128:131], v[104:107], 0
  v_mfma_f32_16x16x32_bf16 v[92:95], v[128:131], v[108:111], 0
  s_waitcnt vmcnt(18)
  v_mfma_f32_16x16x32_bf16 v[16:19], v[148:151], v[132:135], v[16:19]
  v_mfma_f32_16x16x32_bf16 v[20:23], v[148:151], v[136:139], v[20:23]
  buffer_load_dwordx4 v[112:115], v4, s[52:55], s10 offen
  v_mfma_f32_16x16x32_bf16 v[24:27], v[148:151], v[140:143], v[24:27]
  v_mfma_f32_16x16x32_bf16 v[28:31], v[148:151], v[144:147], v[28:31]
  buffer_load_dwordx4 v[96:99], v252, s[48:51], s9 offen
  v_mfma_f32_16x16x32_bf16 v[32:35], v[152:155], v[132:135], v[32:35]
  v_mfma_f32_16x16x32_bf16 v[36:39], v[152:155], v[136:139], v[36:39]
  buffer_load_dwordx4 v[116:119], v5, s[52:55], s10 offen
  v_mfma_f32_16x16x32_bf16 v[40:43], v[152:155], v[140:143], v[40:43]
  v_mfma_f32_16x16x32_bf16 v[44:47], v[152:155], v[144:147], v[44:47]
  buffer_load_dwordx4 v[100:103], v253, s[48:51], s9 offen
  v_mfma_f32_16x16x32_bf16 v[48:51], v[156:159], v[132:135], v[48:51]
  v_mfma_f32_16x16x32_bf16 v[52:55], v[156:159], v[136:139], v[52:55]
  buffer_load_dwordx4 v[120:123], v6, s[52:55], s10 offen
  v_mfma_f32_16x16x32_bf16 v[56:59], v[156:159], v[140:143], v[56:59]
  v_mfma_f32_16x16x32_bf16 v[60:63], v[156:159], v[144:147], v[60:63]
  buffer_load_dwordx4 v[104:107], v254, s[48:51], s9 offen
  v_mfma_f32_16x16x32_bf16 v[64:67], v[160:163], v[132:135], v[64:67]
  v_mfma_f32_16x16x32_bf16 v[68:71], v[160:163], v[136:139], v[68:71]
  buffer_load_dwordx4 v[124:127], v7, s[52:55], s10 offen
  v_mfma_f32_16x16x32_bf16 v[72:75], v[160:163], v[140:143], v[72:75]
  v_mfma_f32_16x16x32_bf16 v[76:79], v[160:163], v[144:147], v[76:79]
  buffer_load_dwordx4 v[108:111], v255, s[48:51], s9 offen
  v_mfma_f32_16x16x32_bf16 v[80:83], v[164:167], v[132:135], v[80:83]
  v_mfma_f32_16x16x32_bf16 v[84:87], v[164:167], v[136:139], v[84:87]
  buffer_load_dwordx4 v[128:131], v8, s[52:55], s10 offen
  s_add_u32 s9, s9, 4096
  s_add_u32 s10, s10, 4096
  v_mfma_f32_16x16x32_bf16 v[88:91], v[164:167], v[140:143], v[88:91]
  v_mfma_f32_16x16x32_bf16 v[92:95], v[164:167], v[144:147], v[92:95]
  s_waitcnt vmcnt(18)
  v_mfma_f32_16x16x32_bf16 v[16:19], v[184:187], v[168:171], v[16:19]
  v_mfma_f32_16x16x32_bf16 v[20:23], v[184:187], v[172:175], v[20:23]
  buffer_load_dwordx4 v[148:151], v4, s[52:55], s10 offen
  v_mfma_f32_16x16x32_bf16 v[24:27], v[184:187], v[176:179], v[24:27]
  v_mfma_f32_16x16x32_bf16 v[28:31], v[184:187], v[180:183], v[28:31]
  buffer_load_dwordx4 v[132:135], v252, s[48:51], s9 offen
  v_mfma_f32_16x16x32_bf16 v[32:35], v[188:191], v[168:171], v[32:35]
  v_mfma_f32_16x16x32_bf16 v[36:39], v[188:191], v[172:175], v[36:39]
  buffer_load_dwordx4 v[152:155], v5, s[52:55], s10 offen
  v_mfma_f32_16x16x32_bf16 v[40:43], v[188:191], v[176:179], v[40:43]
  v_mfma_f32_16x16x32_bf16 v[44:47], v[188:191], v[180:183], v[44:47]
  buffer_load_dwordx4 v[136:139], v253, s[48:51], s9 offen
  v_mfma_f32_16x16x32_bf16 v[48:51], v[192:195], v[168:171], v[48:51]
  v_mfma_f32_16x16x32_bf16 v[52:55], v[192:195], v[172:175], v[52:55]
  buffer_load_dwordx4 v[156:159], v6, s[52:55], s10 offen
  v_mfma_f32_16x16x32_bf16 v[56:59], v[192:195], v[176:179], v[56:59]
  v_mfma_f32_16x16x32_bf16 v[60:63], v[192:195], v[180:183], v[60:63]
  buffer_load_dwordx4 v[140:143], v254, s[48:51], s9 offen
  v_mfma_f32_16x16x32_bf16 v[64:67], v[196:199], v[168:171], v[64:67]
  v_mfma_f32_16x16x32_bf16 v[68:71], v[196:199], v[172:175], v[68:71]
  buffer_load_dwordx4 v[160:163], v7, s[52:55], s10 offen
  v_mfma_f32_16x16x32_bf16 v[72:75], v[196:199], v[176:179], v[72:75]
  v_mfma_f32_16x16x32_bf16 v[76:79], v[196:199], v[180:183], v[76:79]
  buffer_load_dwordx4 v[144:147], v255, s[48:51], s9 offen
  v_mfma_f32_16x16x32_bf16 v[80:83], v[200:203], v[168:171], v[80:83]
  v_mfma_f32_16x16x32_bf16 v[84:87], v[200:203], v[172:175], v[84:87]
  buffer_load_dwordx4 v[164:167], v8, s[52:55], s10 offen
  s_add_u32 s9, s9, 4096
  s_add_u32 s10, s10, 4096
  v_mfma_f32_16x16x32_bf16 v[88:91], v[200:203], v[176:179], v[88:91]
  v_mfma_f32_16x16x32_bf16 v[92:95], v[200:203], v[180:183], v[92:95]
  s_waitcnt vmcnt(18)
  v_mfma_f32_16x16x32_bf16 v[16:19], v[220:223], v[204:207], v[16:19]
  v_mfma_f32_16x16x32_bf16 v[20:23], v[220:223], v[208:211], v[20:23]
  buffer_load_dwordx4 v[184:187], v4, s[52:55], s10 offen
  v_mfma_f32_16x16x32_bf16 v[24:27], v[220:223], v[212:215], v[24:27]
  v_mfma_f32_16x16x32_bf16 v[28:31], v[220:223], v[216:219], v[28:31]
  buffer_load_dwordx4 v[168:171], v252, s[48:51], s9 offen
  v_mfma_f32_16x16x32_bf16 v[32:35], v[224:227], v[204:207], v[32:35]
  v_mfma_f32_16x16x32_bf16 v[36:39], v[224:227], v[208:211], v[36:39]
  buffer_load_dwordx4 v[188:191], v5, s[52:55], s10 offen
  v_mfma_f32_16x16x32_bf16 v[40:43], v[224:227], v[212:215], v[40:43]
  v_mfma_f32_16x16x32_bf16 v[44:47], v[224:227], v[216:219], v[44:47]
  buffer_load_dwordx4 v[172:175], v253, s[48:51], s9 offen
  v_mfma_f32_16x16x32_bf16 v[48:51], v[228:231], v[204:207], v[48:51]
  v_mfma_f32_16x16x32_bf16 v[52:55], v[228:231], v[208:211], v[52:55]
  buffer_load_dwordx4 v[192:195], v6, s[52:55], s10 offen
  v_mfma_f32_16x16x32_bf16 v[56:59], v[228:231], v[212:215], v[56:59]
  v_mfma_f32_16x16x32_bf16 v[60:63], v[228:231], v[216:219], v[60:63]
  buffer_load_dwordx4 v[176:179], v254, s[48:51], s9 offen
  v_mfma_f32_16x16x32_bf16 v[64:67], v[232:235], v[204:207], v[64:67]
  v_mfma_f32_16x16x32_bf16 v[68:71], v[232:235], v[208:211], v[68:71]
  buffer_load_dwordx4 v[196:199], v7, s[52:55], s10 offen
  v_mfma_f32_16x16x32_bf16 v[72:75], v[232:235], v[212:215], v[72:75]
  v_mfma_f32_16x16x32_bf16 v[76:79], v[232:235], v[216:219], v[76:79]
  buffer_load_dwordx4 v[180:183], v255, s[48:51], s9 offen
  v_mfma_f32_16x16x32_bf16 v[80:83], v[236:239], v[204:207], v[80:83]
  v_mfma_f32_16x16x32_bf16 v[84:87], v[236:239], v[208:211], v[84:87]
  buffer_load_dwordx4 v[200:203], v8, s[52:55], s10 offen
  s_add_u32 s9, s9, 4096
  s_add_u32 s10, s10, 4096
  v_mfma_f32_16x16x32_bf16 v[88:91], v[236:239], v[212:215], v[88:91]
  v_mfma_f32_16x16x32_bf16 v[92:95], v[236:239], v[216:219], v[92:95]
  s_waitcnt vmcnt(18)
  v_mfma_f32_16x16x32_bf16 v[16:19], v[112:115], v[96:99], v[16:19]
  v_mfma_f32_16x16x32_bf16 v[20:23], v[112:115], v[100:103], v[20:23]
  buffer_load_dwordx4 v[220:223], v4, s[52:55], s10 offen
  v_mfma_f32_16x16x32_bf16 v[24:27], v[112:115], v[104:107], v[24:27]
  v_mfma_f32_16x16x32_bf16 v[28:31], v[112:115], v[108:111], v[28:31]
  buffer_load_dwordx4 v[204:207], v252, s[48:51], s9 offen
  v_mfma_f32_16x16x32_bf16 v[32:35], v[116:119], v[96:99], v[32:35]
  v_mfma_f32_16x16x32_bf16 v[36:39], v[116:119], v[100:103], v[36:39]
  buffer_load_dwordx4 v[224:227], v5, s[52:55], s10 offen
  v_mfma_f32_16x16x32_bf16 v[40:43], v[116:119], v[104:107], v[40:43]
  v_mfma_f32_16x16x32_bf16 v[44:47], v[116:119], v[108:111], v[44:47]
  buffer_load_dwordx4 v[208:211], v253, s[48:51], s9 offen
  v_mfma_f32_16x16x32_bf16 v[48:51], v[120:123], v[96:99], v[48:51]
  v_mfma_f32_16x16x32_bf16 v[52:55], v[120:123], v[100:103], v[52:55]
  buffer_load_dwordx4 v[228:231], v6, s[52:55], s10 offen
  v_mfma_f32_16x16x32_bf16 v[56:59], v[120:123], v[104:107], v[56:59]
  v_mfma_f32_16x16x32_bf16 v[60:63], v[120:123], v[108:111], v[60:63]
  buffer_load_dwordx4 v[212:215], v254, s[48:51], s9 offen
  v_mfma_f32_16x16x32_bf16 v[64:67], v[124:127], v[96:99], v[64:67]
  v_mfma_f32_16x16x32_bf16 v[68:71], v[124:127], v[100:103], v[68:71]
  buffer_load_dwordx4 v[232:235], v7, s[52:55], s10 offen
  v_mfma_f32_16x16x32_bf16 v[72:75], v[124:127], v[104:107], v[72:75]
  v_mfma_f32_16x16x32_bf16 v[76:79], v[124:127], v[108:111], v[76:79]
  buffer_load_dwordx4 v[216:219], v255, s[48:51], s9 offen
  v_mfma_f32_16x16x32_bf16 v[80:83], v[128:131], v[96:99], v[80:83]
  v_mfma_f32_16x16x32_bf16 v[84:87], v[128:131], v[100:103], v[84:87]
  buffer_load_dwordx4 v[236:239], v8, s[52:55], s10 offen
  s_add_u32 s9, s9, 4096
  s_add_u32 s10, s10, 4096
  v_mfma_f32_16x16x32_bf16 v[88:91], v[128:131], v[104:107], v[88:91]
  v_mfma_f32_16x16x32_bf16 v[92:95], v[128:131], v[108:111], v[92:95]
  s_waitcnt vmcnt(18)
  v_mfma_f32_16x16x32_bf16 v[16:19], v[148:151], v[132:135], v[16:19]
  v_mfma_f32_16x16x32_bf16 v[20:23], v[148:151], v[136:139], v[20:23]
  buffer_load_dwordx4 v[112:115], v4, s[52:55], s10 offen
  v_mfma_f32_16x16x32_bf16 v[24:27], v[148:151], v[140:143], v[24:27]
  v_mfma_f32_16x16x32_bf16 v[28:31], v[148:151], v[144:147], v[28:31]
  buffer_load_dwordx4 v[96:99], v252, s[48:51], s9 offen
  v_mfma_f32_16x16x32_bf16 v[32:35], v[152:155], v[132:135], v[32:35]
  v_mfma_f32_16x16x32_bf16 v[36:39], v[152:155], v[136:139], v[36:39]
  buffer_load_dwordx4 v[116:119], v5, s[52:55], s10 offen
  v_mfma_f32_16x16x32_bf16 v[40:43], v[152:155], v[140:143], v[40:43]
  v_mfma_f32_16x16x32_bf16 v[44:47], v[152:155], v[144:147], v[44:47]
  buffer_load_dwordx4 v[100:103], v253, s[48:51], s9 offen
  v_mfma_f32_16x16x32_bf16 v[48:51], v[156:159], v[132:135], v[48:51]
  v_mfma_f32_16x16x32_bf16 v[52:55], v[156:159], v[136:139], v[52:55]
  buffer_load_dwordx4 v[120:123], v6, s[52:55], s10 offen
  v_mfma_f32_16x16x32_bf16 v[56:59], v[156:159], v[140:143], v[56:59]
  v_mfma_f32_16x16x32_bf16 v[60:63], v[156:159], v[144:147], v[60:63]
  buffer_load_dwordx4 v[104:107], v254, s[48:51], s9 offen
  v_mfma_f32_16x16x32_bf16 v[64:67], v[160:163], v[132:135], v[64:67]
  v_mfma_f32_16x16x32_bf16 v[68:71], v[160:163], v[136:139], v[68:71]
  buffer_load_dwordx4 v[124:127], v7, s[52:55], s10 offen
  v_mfma_f32_16x16x32_bf16 v[72:75], v[160:163], v[140:143], v[72:75]
  v_mfma_f32_16x16x32_bf16 v[76:79], v[160:163], v[144:147], v[76:79]
  buffer_load_dwordx4 v[108:111], v255, s[48:51], s9 offen
  v_mfma_f32_16x16x32_bf16 v[80:83], v[164:167], v[132:135], v[80:83]
  v_mfma_f32_16x16x32_bf16 v[84:87], v[164:167], v[136:139], v[84:87]
  buffer_load_dwordx4 v[128:131], v8, s[52:55], s10 offen
  s_add_u32 s9, s9, 4096
  s_add_u32 s10, s10, 4096
  v_mfma_f32_16x16x32_bf16 v[88:91], v[164:167], v[140:143], v[88:91]
  v_mfma_f32_16x16x32_bf16 v[92:95], v[164:167], v[144:147], v[92:95]
  s_waitcnt vmcnt(18)
  v_mfma_f32_16x16x32_bf16 v[16:19], v[184:187], v[168:171], v[16:19]
  v_mfma_f32_16x16x32_bf16 v[20:23], v[184:187], v[172:175], v[20:23]
  buffer_load_dwordx4 v[148:151], v4, s[52:55], s10 offen
  v_mfma_f32_16x16x32_bf16 v[24:27], v[184:187], v[176:179], v[24:27]
  v_mfma_f32_16x16x32_bf16 v[28:31], v[184:187], v[180:183], v[28:31]
  buffer_load_dwordx4 v[132:135], v252, s[48:51], s9 offen
  v_mfma_f32_16x16x32_bf16 v[32:35], v[188:191], v[168:171], v[32:35]
  v_mfma_f32_16x16x32_bf16 v[36:39], v[188:191], v[172:175], v[36:39]
  buffer_load_dwordx4 v[152:155], v5, s[52:55], s10 offen
  v_mfma_f32_16x16x32_bf16 v[40:43], v[188:191], v[176:179], v[40:43]
  v_mfma_f32_16x16x32_bf16 v[44:47], v[188:191], v[180:183], v[44:47]
  buffer_load_dwordx4 v[136:139], v253, s[48:51], s9 offen
  v_mfma_f32_16x16x32_bf16 v[48:51], v[192:195], v[168:171], v[48:51]
  v_mfma_f32_16x16x32_bf16 v[52:55], v[192:195], v[172:175], v[52:55]
  buffer_load_dwordx4 v[156:159], v6, s[52:55], s10 offen
  v_mfma_f32_16x16x32_bf16 v[56:59], v[192:195], v[176:179], v[56:59]
  v_mfma_f32_16x16x32_bf16 v[60:63], v[192:195], v[180:183], v[60:63]
  buffer_load_dwordx4 v[140:143], v254, s[48:51], s9 offen
  v_mfma_f32_16x16x32_bf16 v[64:67], v[196:199], v[168:171], v[64:67]
  v_mfma_f32_16x16x32_bf16 v[68:71], v[196:199], v[172:175], v[68:71]
  buffer_load_dwordx4 v[160:163], v7, s[52:55], s10 offen
  v_mfma_f32_16x16x32_bf16 v[72:75], v[196:199], v[176:179], v[72:75]
  v_mfma_f32_16x16x32_bf16 v[76:79], v[196:199], v[180:183], v[76:79]
  buffer_load_dwordx4 v[144:147], v255, s[48:51], s9 offen
  v_mfma_f32_16x16x32_bf16 v[80:83], v[200:203], v[168:171], v[80:83]
  v_mfma_f32_16x16x32_bf16 v[84:87], v[200:203], v[172:175], v[84:87]
  buffer_load_dwordx4 v[164:167], v8, s[52:55], s10 offen
  s_add_u32 s9, s9, 4096
  s_add_u32 s10, s10, 4096
  v_mfma_f32_16x16x32_bf16 v[88:91], v[200:203], v[176:179], v[88:91]
  v_mfma_f32_16x16x32_bf16 v[92:95], v[200:203], v[180:183], v[92:95]
  s_waitcnt vmcnt(18)
  v_mfma_f32_16x16x32_bf16 v[16:19], v[220:223], v[204:207], v[16:19]
  v_mfma_f32_16x16x32_bf16 v[20:23], v[220:223], v[208:211], v[20:23]
  buffer_load_dwordx4 v[184:187], v4, s[52:55], s10 offen
  v_mfma_f32_16x16x32_bf16 v[24:27], v[220:223], v[212:215], v[24:27]
  v_mfma_f32_16x16x32_bf16 v[28:31], v[220:223], v[216:219], v[28:31]
  buffer_load_dwordx4 v[168:171], v252, s[48:51], s9 offen
  v_mfma_f32_16x16x32_bf16 v[32:35], v[224:227], v[204:207], v[32:35]
  v_mfma_f32_16x16x32_bf16 v[36:39], v[224:227], v[208:211], v[36:39]
  buffer_load_dwordx4 v[188:191], v5, s[52:55], s10 offen
  v_mfma_f32_16x16x32_bf16 v[40:43], v[224:227], v[212:215], v[40:43]
  v_mfma_f32_16x16x32_bf16 v[44:47], v[224:227], v[216:219], v[44:47]
  buffer_load_dwordx4 v[172:175], v253, s[48:51], s9 offen
  v_mfma_f32_16x16x32_bf16 v[48:51], v[228:231], v[204:207], v[48:51]
  v_mfma_f32_16x16x32_bf16 v[52:55], v[228:231], v[208:211], v[52:55]
  buffer_load_dwordx4 v[192:195], v6, s[52:55], s10 offen
  v_mfma_f32_16x16x32_bf16 v[56:59], v[228:231], v[212:215], v[56:59]
  v_mfma_f32_16x16x32_bf16 v[60:63], v[228:231], v[216:219], v[60:63]
  buffer_load_dwordx4 v[176:179], v254, s[48:51], s9 offen
  v_mfma_f32_16x16x32_bf16 v[64:67], v[232:235], v[204:207], v[64:67]
  v_mfma_f32_16x16x32_bf16 v[68:71], v[232:235], v[208:211], v[68:71]
  buffer_load_dwordx4 v[196:199], v7, s[52:55], s10 offen
  v_mfma_f32_16x16x32_bf16 v[72:75], v[232:235], v[212:215], v[72:75]
  v_mfma_f32_16x16x32_bf16 v[76:79], v[232:235], v[216:219], v[76:79]
  buffer_load_dwordx4 v[180:183], v255, s[48:51], s9 offen
  v_mfma_f32_16x16x32_bf16 v[80:83], v[236:239], v[204:207], v[80:83]
  v_mfma_f32_16x16x32_bf16 v[84:87], v[236:239], v[208:211], v[84:87]
  buffer_load_dwordx4 v[200:203], v8, s[52:55], s10 offen
  s_add_u32 s9, s9, 4096
  s_add_u32 s10, s10, 4096
  v_mfma_f32_16x16x32_bf16 v[88:91], v[236:239], v[212:215], v[88:91]
  v_mfma_f32_16x16x32_bf16 v[92:95], v[236:239], v[216:219], v[92:95]
  s_waitcnt vmcnt(18)
  v_mfma_f32_16x16x32_bf16 v[16:19], v[112:115], v[96:99], v[16:19]
  v_mfma_f32_16x16x32_bf16 v[20:23], v[112:115], v[100:103], v[20:23]
  buffer_load_dwordx4 v[220:223], v4, s[52:55], s10 offen
  v_mfma_f32_16x16x32_bf16 v[24:27], v[112:115], v[104:107], v[24:27]
  v_mfma_f32_16x16x32_bf16 v[28:31], v[112:115], v[108:111], v[28:31]
  buffer_load_dwordx4 v[204:207], v252, s[48:51], s9 offen
  v_mfma_f32_16x16x32_bf16 v[32:35], v[116:119], v[96:99], v[32:35]
  v_mfma_f32_16x16x32_bf16 v[36:39], v[116:119], v[100:103], v[36:39]
  buffer_load_dwordx4 v[224:227], v5, s[52:55], s10 offen
  v_mfma_f32_16x16x32_bf16 v[40:43], v[116:119], v[104:107], v[40:43]
  v_mfma_f32_16x16x32_bf16 v[44:47], v[116:119], v[108:111], v[44:47]
  buffer_load_dwordx4 v[208:211], v253, s[48:51], s9 offen
  v_mfma_f32_16x16x32_bf16 v[48:51], v[120:123], v[96:99], v[48:51]
  v_mfma_f32_16x16x32_bf16 v[52:55], v[120:123], v[100:103], v[52:55]
  buffer_load_dwordx4 v[228:231], v6, s[52:55], s10 offen
  v_mfma_f32_16x16x32_bf16 v[56:59], v[120:123], v[104:107], v[56:59]
  v_mfma_f32_16x16x32_bf16 v[60:63], v[120:123], v[108:111], v[60:63]
  buffer_load_dwordx4 v[212:215], v254, s[48:51], s9 offen
  v_mfma_f32_16x16x32_bf16 v[64:67], v[124:127], v[96:99], v[64:67]
  v_mfma_f32_16x16x32_bf16 v[68:71], v[124:127], v[100:103], v[68:71]
  buffer_load_dwordx4 v[232:235], v7, s[52:55], s10 offen
  v_mfma_f32_16x16x32_bf16 v[72:75], v[124:127], v[104:107], v[72:75]
  v_mfma_f32_16x16x32_bf16 v[76:79], v[124:127], v[108:111], v[76:79]
  buffer_load_dwordx4 v[216:219], v255, s[48:51], s9 offen
  v_mfma_f32_16x16x32_bf16 v[80:83], v[128:131], v[96:99], v[80:83]
  v_mfma_f32_16x16x32_bf16 v[84:87], v[128:131], v[100:103], v[84:87]
  buffer_load_dwordx4 v[236:239], v8, s[52:55], s10 offen
  s_add_u32 s9, s9, 4096
  s_add_u32 s10, s10, 4096
  v_mfma_f32_16x16x32_bf16 v[88:91], v[128:131], v[104:107], v[88:91]
  v_mfma_f32_16x16x32_bf16 v[92:95], v[128:131], v[108:111], v[92:95]
  s_waitcnt vmcnt(18)
  v_mfma_f32_16x16x32_bf16 v[16:19], v[148:151], v[132:135], v[16:19]
  v_mfma_f32_16x16x32_bf16 v[20:23], v[148:151], v[136:139], v[20:23]
  buffer_load_dwordx4 v[112:115], v4, s[52:55], s10 offen
  v_mfma_f32_16x16x32_bf16 v[24:27], v[148:151], v[140:143], v[24:27]
  v_mfma_f32_16x16x32_bf16 v[28:31], v[148:151], v[144:147], v[28:31]
  buffer_load_dwordx4 v[96:99], v252, s[48:51], s9 offen
  v_mfma_f32_16x16x32_bf16 v[32:35], v[152:155], v[132:135], v[32:35]
  v_mfma_f32_16x16x32_bf16 v[36:39], v[152:155], v[136:139], v[36:39]
  buffer_load_dwordx4 v[116:119], v5, s[52:55], s10 offen
  v_mfma_f32_16x16x32_bf16 v[40:43], v[152:155], v[140:143], v[40:43]
  v_mfma_f32_16x16x32_bf16 v[44:47], v[152:155], v[144:147], v[44:47]
  buffer_load_dwordx4 v[100:103], v253, s[48:51], s9 offen
  v_mfma_f32_16x16x32_bf16 v[48:51], v[156:159], v[132:135], v[48:51]
  v_mfma_f32_16x16x32_bf16 v[52:55], v[156:159], v[136:139], v[52:55]
  buffer_load_dwordx4 v[120:123], v6, s[52:55], s10 offen
  v_mfma_f32_16x16x32_bf16 v[56:59], v[156:159], v[140:143], v[56:59]
  v_mfma_f32_16x16x32_bf16 v[60:63], v[156:159], v[144:147], v[60:63]
  buffer_load_dwordx4 v[104:107], v254, s[48:51], s9 offen
  v_mfma_f32_16x16x32_bf16 v[64:67], v[160:163], v[132:135], v[64:67]
  v_mfma_f32_16x16x32_bf16 v[68:71], v[160:163], v[136:139], v[68:71]
  buffer_load_dwordx4 v[124:127], v7, s[52:55], s10 offen
  v_mfma_f32_16x16x32_bf16 v[72:75], v[160:163], v[140:143], v[72:75]
  v_mfma_f32_16x16x32_bf16 v[76:79], v[160:163], v[144:147], v[76:79]
  buffer_load_dwordx4 v[108:111], v255, s[48:51], s9 offen
  v_mfma_f32_16x16x32_bf16 v[80:83], v[164:167], v[132:135], v[80:83]
  v_mfma_f32_16x16x32_bf16 v[84:87], v[164:167], v[136:139], v[84:87]
  buffer_load_dwordx4 v[128:131], v8, s[52:55], s10 offen
  s_add_u32 s9, s9, 4096
  s_add_u32 s10, s10, 4096
  v_mfma_f32_16x16x32_bf16 v[88:91], v[164:167], v[140:143], v[88:91]
  v_mfma_f32_16x16x32_bf16 v[92:95], v[164:167], v[144:147], v[92:95]
  s_waitcnt vmcnt(18)
  v_mfma_f32_16x16x32_bf16 v[16:19], v[184:187], v[168:171], v[16:19]
  v_mfma_f32_16x16x32_bf16 v[20:23], v[184:187], v[172:175], v[20:23]
  s_cmp_lt_u32 s8, 2
  s_cselect_b32 s9, s9, 0x7f000000
  s_cselect_b32 s10, s10, 0x7f000000
  buffer_load_dwordx4 v[148:151], v4, s[52:55], s10 offen
  v_mfma_f32_16x16x32_bf16 v[24:27], v[184:187], v[176:179], v[24:27]
  v_mfma_f32_16x16x32_bf16 v[28:31], v[184:187], v[180:183], v[28:31]
  buffer_load_dwordx4 v[132:135], v252, s[48:51], s9 offen
  v_mfma_f32_16x16x32_bf16 v[32:35], v[188:191], v[168:171], v[32:35]
  v_mfma_f32_16x16x32_bf16 v[36:39], v[188:191], v[172:175], v[36:39]
  buffer_load_dwordx4 v[152:155], v5, s[52:55], s10 offen
  v_mfma_f32_16x16x32_bf16 v[40:43], v[188:191], v[176:179], v[40:43]
  v_mfma_f32_16x16x32_bf16 v[44:47], v[188:191], v[180:183], v[44:47]
  buffer_load_dwordx4 v[136:139], v253, s[48:51], s9 offen
  v_mfma_f32_16x16x32_bf16 v[48:51], v[192:195], v[168:171], v[48:51]
  v_mfma_f32_16x16x32_bf16 v[52:55], v[192:195], v[172:175], v[52:55]
  buffer_load_dwordx4 v[156:159], v6, s[52:55], s10 offen
  v_mfma_f32_16x16x32_bf16 v[56:59], v[192:195], v[176:179], v[56:59]
  v_mfma_f32_16x16x32_bf16 v[60:63], v[192:195], v[180:183], v[60:63]
  buffer_load_dwordx4 v[140:143], v254, s[48:51], s9 offen
  v_mfma_f32_16x16x32_bf16 v[64:67], v[196:199], v[168:171], v[64:67]
  v_mfma_f32_16x16x32_bf16 v[68:71], v[196:199], v[172:175], v[68:71]
  buffer_load_dwordx4 v[160:163], v7, s[52:55], s10 offen
  v_mfma_f32_16x16x32_bf16 v[72:75], v[196:199], v[176:179], v[72:75]
  v_mfma_f32_16x16x32_bf16 v[76:79], v[196:199], v[180:183], v[76:79]
  buffer_load_dwordx4 v[144:147], v255, s[48:51], s9 offen
  v_mfma_f32_16x16x32_bf16 v[80:83], v[200:203], v[168:171], v[80:83]
  v_mfma_f32_16x16x32_bf16 v[84:87], v[200:203], v[172:175], v[84:87]
  buffer_load_dwordx4 v[164:167], v8, s[52:55], s10 offen
  v_mfma_f32_16x16x32_bf16 v[88:91], v[200:203], v[176:179], v[88:91]
  v_mfma_f32_16x16x32_bf16 v[92:95], v[200:203], v[180:183], v[92:95]
  s_waitcnt vmcnt(18)
  v_mfma_f32_16x16x32_bf16 v[16:19], v[220:223], v[204:207], v[16:19]
  v_mfma_f32_16x16x32_bf16 v[20:23], v[220:223], v[208:211], v[20:23]
  buffer_load_dwordx2 v[240:241], v13, s[60:63], 0 offen offset:0
  v_mfma_f32_16x16x32_bf16 v[24:27], v[220:223], v[212:215], v[24:27]
  v_mfma_f32_16x16x32_bf16 v[28:31], v[220:223], v[216:219], v[28:31]
  buffer_load_dwordx2 v[242:243], v13, s[60:63], 0 offen offset:32
  v_mfma_f32_16x16x32_bf16 v[32:35], v[224:227], v[204:207], v[32:35]
  v_mfma_f32_16x16x32_bf16 v[36:39], v[224:227], v[208:211], v[36:39]
  buffer_load_dwordx2 v[244:245], v13, s[60:63], 0 offen offset:64
  v_mfma_f32_16x16x32_bf16 v[40:43], v[224:227], v[212:215], v[40:43]
  v_mfma_f32_16x16x32_bf16 v[44:47], v[224:227], v[216:219], v[44:47]
  buffer_load_dwordx2 v[246:247], v13, s[60:63], 0 offen offset:96
  v_mfma_f32_16x16x32_bf16 v[48:51], v[228:231], v[204:207], v[48:51]
  v_mfma_f32_16x16x32_bf16 v[52:55], v[228:231], v[208:211], v[52:55]
  buffer_load_dwordx2 v[248:249], v13, s[60:63], 0 offen offset:128
  v_mfma_f32_16x16x32_bf16 v[56:59], v[228:231], v[212:215], v[56:59]
  v_mfma_f32_16x16x32_bf16 v[60:63], v[228:231], v[216:219], v[60:63]
  v_mfma_f32_16x16x32_bf16 v[64:67], v[232:235], v[204:207], v[64:67]
  v_mfma_f32_16x16x32_bf16 v[68:71], v[232:235], v[208:211], v[68:71]
  v_mfma_f32_16x16x32_bf16 v[72:75], v[232:235], v[212:215], v[72:75]
  v_mfma_f32_16x16x32_bf16 v[76:79], v[232:235], v[216:219], v[76:79]
  v_mfma_f32_16x16x32_bf16 v[80:83], v[236:239], v[204:207], v[80:83]
  v_mfma_f32_16x16x32_bf16 v[84:87], v[236:239], v[208:211], v[84:87]
  v_mfma_f32_16x16x32_bf16 v[88:91], v[236:239], v[212:215], v[88:91]
  v_mfma_f32_16x16x32_bf16 v[92:95], v[236:239], v[216:219], v[92:95]
  s_waitcnt vmcnt(14)
  v_mfma_f32_16x16x32_bf16 v[16:19], v[112:115], v[96:99], v[16:19]
  v_mfma_f32_16x16x32_bf16 v[20:23], v[112:115], v[100:103], v[20:23]
  buffer_load_dword v250, v251, s[68:71], s72 offen sc1
  v_mfma_f32_16x16x32_bf16 v[24:27], v[112:115], v[104:107], v[24:27]
  v_mfma_f32_16x16x32_bf16 v[28:31], v[112:115], v[108:111], v[28:31]
  v_mfma_f32_16x16x32_bf16 v[32:35], v[116:119], v[96:99], v[32:35]
  v_mfma_f32_16x16x32_bf16 v[36:39], v[116:119], v[100:103], v[36:39]
  v_mfma_f32_16x16x32_bf16 v[40:43], v[116:119], v[104:107], v[40:43]
  v_mfma_f32_16x16x32_bf16 v[44:47], v[116:119], v[108:111], v[44:47]
  v_mfma_f32_16x16x32_bf16 v[48:51], v[120:123], v[96:99], v[48:51]
  v_mfma_f32_16x16x32_bf16 v[52:55], v[120:123], v[100:103], v[52:55]
  v_mfma_f32_16x16x32_bf16 v[56:59], v[120:123], v[104:107], v[56:59]
  v_mfma_f32_16x16x32_bf16 v[60:63], v[120:123], v[108:111], v[60:63]
  v_mfma_f32_16x16x32_bf16 v[64:67], v[124:127], v[96:99], v[64:67]
  v_mfma_f32_16x16x32_bf16 v[68:71], v[124:127], v[100:103], v[68:71]
  v_mfma_f32_16x16x32_bf16 v[72:75], v[124:127], v[104:107], v[72:75]
  v_mfma_f32_16x16x32_bf16 v[76:79], v[124:127], v[108:111], v[76:79]
  v_mfma_f32_16x16x32_bf16 v[80:83], v[128:131], v[96:99], v[80:83]
  v_mfma_f32_16x16x32_bf16 v[84:87], v[128:131], v[100:103], v[84:87]
  v_mfma_f32_16x16x32_bf16 v[88:91], v[128:131], v[104:107], v[88:91]
  v_mfma_f32_16x16x32_bf16 v[92:95], v[128:131], v[108:111], v[92:95]
  s_waitcnt vmcnt(6)
  v_mfma_f32_16x16x32_bf16 v[16:19], v[148:151], v[132:135], v[16:19]
  v_mfma_f32_16x16x32_bf16 v[20:23], v[148:151], v[136:139], v[20:23]
  v_mfma_f32_16x16x32_bf16 v[24:27], v[148:151], v[140:143], v[24:27]
  v_mfma_f32_16x16x32_bf16 v[28:31], v[148:151], v[144:147], v[28:31]
  v_mfma_f32_16x16x32_bf16 v[32:35], v[152:155], v[132:135], v[32:35]
  v_mfma_f32_16x16x32_bf16 v[36:39], v[152:155], v[136:139], v[36:39]
  v_mfma_f32_16x16x32_bf16 v[40:43], v[152:155], v[140:143], v[40:43]
  v_mfma_f32_16x16x32_bf16 v[44:47], v[152:155], v[144:147], v[44:47]
  v_mfma_f32_16x16x32_bf16 v[48:51], v[156:159], v[132:135], v[48:51]
  v_mfma_f32_16x16x32_bf16 v[52:55], v[156:159], v[136:139], v[52:55]
  v_mfma_f32_16x16x32_bf16 v[56:59], v[156:159], v[140:143], v[56:59]
  v_mfma_f32_16x16x32_bf16 v[60:63], v[156:159], v[144:147], v[60:63]
  v_mfma_f32_16x16x32_bf16 v[64:67], v[160:163], v[132:135], v[64:67]
  v_mfma_f32_16x16x32_bf16 v[68:71], v[160:163], v[136:139], v[68:71]
  v_mfma_f32_16x16x32_bf16 v[72:75], v[160:163], v[140:143], v[72:75]
  v_mfma_f32_16x16x32_bf16 v[76:79], v[160:163], v[144:147], v[76:79]
  v_mfma_f32_16x16x32_bf16 v[80:83], v[164:167], v[132:135], v[80:83]
  v_mfma_f32_16x16x32_bf16 v[84:87], v[164:167], v[136:139], v[84:87]
  v_mfma_f32_16x16x32_bf16 v[88:91], v[164:167], v[140:143], v[88:91]
  v_mfma_f32_16x16x32_bf16 v[92:95], v[164:167], v[144:147], v[92:95]
  s_waitcnt vmcnt(0)
  v_cmp_eq_u32 vcc, 1, v250
  s_nop 0
  s_cmp_eq_u64 vcc, -1
  s_cselect_b32 s75, 1, 0
  s_cselect_b32 s73, 0, 0x7f000000
  buffer_load_dwordx4 v[168:171], v14, s[56:59], s73 offen sc1
  s_add_u32 s74, s73, 0x20000
  buffer_load_dwordx4 v[172:175], v14, s[56:59], s74 offen sc1
  buffer_load_dwordx4 v[176:179], v15, s[56:59], s73 offen sc1
  s_add_u32 s13, s8, 1
  s_and_b32 s13, s13, 3
  s_mul_i32 s13, s13, 15360
  v_add_u32 v9, s13, v4
  ds_write_b128 v9, v[20:23] offset:0
  ds_write_b128 v9, v[36:39] offset:1024
  ds_write_b128 v9, v[52:55] offset:2048
  ds_write_b128 v9, v[68:71] offset:3072
  ds_write_b128 v9, v[84:87] offset:4096
  s_add_u32 s13, s8, 2
  s_and_b32 s13, s13, 3
  s_mul_i32 s13, s13, 15360
  v_add_u32 v9, s13, v4
  ds_write_b128 v9, v[24:27] offset:5120
  ds_write_b128 v9, v[40:43] offset:6144
  ds_write_b128 v9, v[56:59] offset:7168
  ds_write_b128 v9, v[72:75] offset:8192
  ds_write_b128 v9, v[88:91] offset:9216
  s_add_u32 s13, s8, 3
  s_and_b32 s13, s13, 3
  s_mul_i32 s13, s13, 15360
  v_add_u32 v9, s13, v4
  ds_write_b128 v9, v[28:31] offset:10240
  ds_write_b128 v9, v[44:47] offset:11264
  ds_write_b128 v9, v[60:63] offset:12288
  ds_write_b128 v9, v[76:79] offset:13312
  ds_write_b128 v9, v[92:95] offset:14336
  s_mul_i32 s13, s8, 15360
  v_add_u32 v9, s13, v4
  s_waitcnt lgkmcnt(0)
  s_barrier
  ds_read_b128 v[96:99], v9 offset:0
  ds_read_b128 v[100:103], v9 offset:1024
  ds_read_b128 v[104:107], v9 offset:2048
  ds_read_b128 v[108:111], v9 offset:3072
  ds_read_b128 v[112:115], v9 offset:4096
  ds_read_b128 v[116:119], v9 offset:5120
  ds_read_b128 v[120:123], v9 offset:6144
  ds_read_b128 v[124:127], v9 offset:7168
  ds_read_b128 v[128:131], v9 offset:8192
  ds_read_b128 v[132:135], v9 offset:9216
  ds_read_b128 v[136:139], v9 offset:10240
  ds_read_b128 v[140:143], v9 offset:11264
  ds_read_b128 v[144:147], v9 offset:12288
  ds_read_b128 v[148:151], v9 offset:13312
  ds_read_b128 v[152:155], v9 offset:14336
  v_mov_b32 v10, 1.0
  v_mov_b32 v11, 1.0
  v_mov_b32 v12, 3216550459
  s_waitcnt lgkmcnt(10)
  v_pk_add_f32 v[16:17], v[16:17], v[96:97]
  v_pk_add_f32 v[18:19], v[18:19], v[98:99]
  v_pk_add_f32 v[32:33], v[32:33], v[100:101]
  v_pk_add_f32 v[34:35], v[34:35], v[102:103]
  v_pk_add_f32 v[48:49], v[48:49], v[104:105]
  v_pk_add_f32 v[50:51], v[50:51], v[106:107]
  v_pk_add_f32 v[64:65], v[64:65], v[108:109]
  v_pk_add_f32 v[66:67], v[66:67], v[110:111]
  v_pk_add_f32 v[80:81], v[80:81], v[112:113]
  v_pk_add_f32 v[82:83], v[82:83], v[114:115]
  s_waitcnt lgkmcnt(5)
  v_pk_add_f32 v[16:17], v[16:17], v[116:117]
  v_pk_add_f32 v[18:19], v[18:19], v[118:119]
  v_pk_add_f32 v[32:33], v[32:33], v[120:121]
  v_pk_add_f32 v[34:35], v[34:35], v[122:123]
  v_pk_add_f32 v[48:49], v[48:49], v[124:125]
  v_pk_add_f32 v[50:51], v[50:51], v[126:127]
  v_pk_add_f32 v[64:65], v[64:65], v[128:129]
  v_pk_add_f32 v[66:67], v[66:67], v[130:131]
  v_pk_add_f32 v[80:81], v[80:81], v[132:133]
  v_pk_add_f32 v[82:83], v[82:83], v[134:135]
  s_waitcnt lgkmcnt(0)
  v_pk_add_f32 v[16:17], v[16:17], v[136:137]
  v_pk_add_f32 v[18:19], v[18:19], v[138:139]
  v_pk_add_f32 v[32:33], v[32:33], v[140:141]
  v_pk_add_f32 v[34:35], v[34:35], v[142:143]
  v_pk_add_f32 v[48:49], v[48:49], v[144:145]
  v_pk_add_f32 v[50:51], v[50:51], v[146:147]
  v_pk_add_f32 v[64:65], v[64:65], v[148:149]
  v_pk_add_f32 v[66:67], v[66:67], v[150:151]
  v_pk_add_f32 v[80:81], v[80:81], v[152:153]
  v_pk_add_f32 v[82:83], v[82:83], v[154:155]
  v_cvt_pk_bf16_f32 v96, v16, v17
  v_cvt_pk_bf16_f32 v98, v18, v19
  v_cvt_pk_bf16_f32 v100, v32, v33
  v_cvt_pk_bf16_f32 v102, v34, v35
  v_cvt_pk_bf16_f32 v104, v48, v49
  v_cvt_pk_bf16_f32 v106, v50, v51
  v_cvt_pk_bf16_f32 v108, v64, v65
  v_cvt_pk_bf16_f32 v110, v66, v67
  v_cvt_pk_bf16_f32 v112, v80, v81
  v_cvt_pk_bf16_f32 v114, v82, v83
  v_lshlrev_b32 v16, 16, v96
  v_and_b32 v17, 0xffff0000, v96
  v_lshlrev_b32 v18, 16, v98
  v_and_b32 v19, 0xffff0000, v98
  v_lshlrev_b32 v32, 16, v100
  v_and_b32 v33, 0xffff0000, v100
  v_lshlrev_b32 v34, 16, v102
  v_and_b32 v35, 0xffff0000, v102
  v_lshlrev_b32 v48, 16, v104
  v_and_b32 v49, 0xffff0000, v104
  v_lshlrev_b32 v50, 16, v106
  v_and_b32 v51, 0xffff0000, v106
  v_lshlrev_b32 v64, 16, v108
  v_and_b32 v65, 0xffff0000, v108
  v_lshlrev_b32 v66, 16, v110
  v_and_b32 v67, 0xffff0000, v110
  v_lshlrev_b32 v80, 16, v112
  v_and_b32 v81, 0xffff0000, v112
  v_lshlrev_b32 v82, 16, v114
  v_and_b32 v83, 0xffff0000, v114
  v_pk_mul_f32 v[96:97], v[16:17], v[12:13] op_sel_hi:[1,0]
  v_pk_mul_f32 v[98:99], v[18:19], v[12:13] op_sel_hi:[1,0]
  v_pk_mul_f32 v[100:101], v[32:33], v[12:13] op_sel_hi:[1,0]
  v_pk_mul_f32 v[102:103], v[34:35], v[12:13] op_sel_hi:[1,0]
  v_pk_mul_f32 v[104:105], v[48:49], v[12:13] op_sel_hi:[1,0]
  v_pk_mul_f32 v[106:107], v[50:51], v[12:13] op_sel_hi:[1,0]
  v_pk_mul_f32 v[108:109], v[64:65], v[12:13] op_sel_hi:[1,0]
  v_pk_mul_f32 v[110:111], v[66:67], v[12:13] op_sel_hi:[1,0]
  v_pk_mul_f32 v[112:113], v[80:81], v[12:13] op_sel_hi:[1,0]
  v_pk_mul_f32 v[114:115], v[82:83], v[12:13] op_sel_hi:[1,0]
  v_exp_f32 v96, v96
  v_exp_f32 v97, v97
  v_exp_f32 v98, v98
  v_exp_f32 v99, v99
  v_exp_f32 v100, v100
  v_exp_f32 v101, v101
  v_exp_f32 v102, v102
  v_exp_f32 v103, v103
  v_exp_f32 v104, v104
  v_exp_f32 v105, v105
  v_exp_f32 v106, v106
  v_exp_f32 v107, v107
  v_exp_f32 v108, v108
  v_exp_f32 v109, v109
  v_exp_f32 v110, v110
  v_exp_f32 v111, v111
  v_exp_f32 v112, v112
  v_exp_f32 v113, v113
  v_exp_f32 v114, v114
  v_exp_f32 v115, v115
  v_pk_add_f32 v[96:97], v[96:97], v[10:11]
  v_pk_add_f32 v[98:99], v[98:99], v[10:11]
  v_pk_add_f32 v[100:101], v[100:101], v[10:11]
  v_pk_add_f32 v[102:103], v[102:103], v[10:11]
  v_pk_add_f32 v[104:105], v[104:105], v[10:11]
  v_pk_add_f32 v[106:107], v[106:107], v[10:11]
  v_pk_add_f32 v[108:109], v[108:109], v[10:11]
  v_pk_add_f32 v[110:111], v[110:111], v[10:11]
  v_pk_add_f32 v[112:113], v[112:113], v[10:11]
  v_pk_add_f32 v[114:115], v[114:115], v[10:11]
  v_rcp_f32 v96, v96
  v_rcp_f32 v97, v97
  v_rcp_f32 v98, v98
  v_rcp_f32 v99, v99
  v_rcp_f32 v100, v100
  v_rcp_f32 v101, v101
  v_rcp_f32 v102, v102
  v_rcp_f32 v103, v103
  v_rcp_f32 v104, v104
  v_rcp_f32 v105, v105
  v_rcp_f32 v106, v106
  v_rcp_f32 v107, v107
  v_rcp_f32 v108, v108
  v_rcp_f32 v109, v109
  v_rcp_f32 v110, v110
  v_rcp_f32 v111, v111
  v_rcp_f32 v112, v112
  v_rcp_f32 v113, v113
  v_rcp_f32 v114, v114
  v_rcp_f32 v115, v115
  v_pk_mul_f32 v[96:97], v[96:97], v[16:17]
  v_pk_mul_f32 v[98:99], v[98:99], v[18:19]
  v_pk_mul_f32 v[100:101], v[100:101], v[32:33]
  v_pk_mul_f32 v[102:103], v[102:103], v[34:35]
  v_pk_mul_f32 v[104:105], v[104:105], v[48:49]
  v_pk_mul_f32 v[106:107], v[106:107], v[50:51]
  v_pk_mul_f32 v[108:109], v[108:109], v[64:65]
  v_pk_mul_f32 v[110:111], v[110:111], v[66:67]
  v_pk_mul_f32 v[112:113], v[112:113], v[80:81]
  v_pk_mul_f32 v[114:115], v[114:115], v[82:83]
  v_cvt_pk_bf16_f32 v96, v96, v97
  v_cvt_pk_bf16_f32 v98, v98, v99
  v_cvt_pk_bf16_f32 v100, v100, v101
  v_cvt_pk_bf16_f32 v102, v102, v103
  v_cvt_pk_bf16_f32 v104, v104, v105
  v_cvt_pk_bf16_f32 v106, v106, v107
  v_cvt_pk_bf16_f32 v108, v108, v109
  v_cvt_pk_bf16_f32 v110, v110, v111
  v_cvt_pk_bf16_f32 v112, v112, v113
  v_cvt_pk_bf16_f32 v114, v114, v115
  v_lshlrev_b32 v16, 16, v96
  v_and_b32 v17, 0xffff0000, v96
  v_lshlrev_b32 v18, 16, v98
  v_and_b32 v19, 0xffff0000, v98
  v_lshlrev_b32 v32, 16, v100
  v_and_b32 v33, 0xffff0000, v100
  v_lshlrev_b32 v34, 16, v102
  v_and_b32 v35, 0xffff0000, v102
  v_lshlrev_b32 v48, 16, v104
  v_and_b32 v49, 0xffff0000, v104
  v_lshlrev_b32 v50, 16, v106
  v_and_b32 v51, 0xffff0000, v106
  v_lshlrev_b32 v64, 16, v108
  v_and_b32 v65, 0xffff0000, v108
  v_lshlrev_b32 v66, 16, v110
  v_and_b32 v67, 0xffff0000, v110
  v_lshlrev_b32 v80, 16, v112
  v_and_b32 v81, 0xffff0000, v112
  v_lshlrev_b32 v82, 16, v114
  v_and_b32 v83, 0xffff0000, v114
  v_lshlrev_b32 v116, 16, v240
  v_and_b32 v117, 0xffff0000, v240
  v_lshlrev_b32 v118, 16, v241
  v_and_b32 v119, 0xffff0000, v241
  v_lshlrev_b32 v120, 16, v242
  v_and_b32 v121, 0xffff0000, v242
  v_lshlrev_b32 v122, 16, v243
  v_and_b32 v123, 0xffff0000, v243
  v_lshlrev_b32 v124, 16, v244
  v_and_b32 v125, 0xffff0000, v244
  v_lshlrev_b32 v126, 16, v245
  v_and_b32 v127, 0xffff0000, v245
  v_lshlrev_b32 v128, 16, v246
  v_and_b32 v129, 0xffff0000, v246
  v_lshlrev_b32 v130, 16, v247
  v_and_b32 v131, 0xffff0000, v247
  v_lshlrev_b32 v132, 16, v248
  v_and_b32 v133, 0xffff0000, v248
  v_lshlrev_b32 v134, 16, v249
  v_and_b32 v135, 0xffff0000, v249
  s_mul_i32 s13, s8, 3072
  v_add_u32 v9, s13, v4
  v_lshlrev_b32 v10, 3, v2
  v_add_u32 v10, s13, v10
  s_cmp_lg_u32 s75, 0
  s_cbranch_scc1 g2ok_15
g2spin_16:
  buffer_load_dword v250, v251, s[68:71], s72 offen sc1
  s_waitcnt vmcnt(0)
  v_cmp_eq_u32 vcc, 1, v250
  s_nop 0
  s_cmp_eq_u64 vcc, -1
  s_cselect_b32 s75, 1, 0
  s_cselect_b32 s73, 0, 0x7f000000
  s_cmp_lg_u32 s75, 0
  s_cbranch_scc1 g2got_17
  s_sleep 16
  s_branch g2spin_16
g2got_17:
  buffer_load_dwordx4 v[168:171], v14, s[56:59], s73 offen sc1
  s_add_u32 s74, s73, 0x20000
  buffer_load_dwordx4 v[172:175], v14, s[56:59], s74 offen sc1
  buffer_load_dwordx4 v[176:179], v15, s[56:59], s73 offen sc1
g2ok_15:
  s_waitcnt vmcnt(0)
  ds_write_b128 v9, v[168:171] offset:61440
  ds_write_b128 v9, v[172:175] offset:62464
  ds_write_b128 v9, v[176:179] offset:63488
  ds_read_b64_tr_b16 v[168:169], v10 offset:61440
  ds_read_b64_tr_b16 v[170:171], v10 offset:61952
  ds_read_b64_tr_b16 v[172:173], v10 offset:62464
  ds_read_b64_tr_b16 v[174:175], v10 offset:62976
  ds_read_b64_tr_b16 v[176:177], v10 offset:63488
  s_waitcnt lgkmcnt(0)
  v_lshlrev_b32 v96, 16, v168
  v_and_b32 v97, 0xffff0000, v168
  v_lshlrev_b32 v98, 16, v169
  v_and_b32 v99, 0xffff0000, v169
  v_lshlrev_b32 v100, 16, v170
  v_and_b32 v101, 0xffff0000, v170
  v_lshlrev_b32 v102, 16, v171
  v_and_b32 v103, 0xffff0000, v171
  v_lshlrev_b32 v104, 16, v172
  v_and_b32 v105, 0xffff0000, v172
  v_lshlrev_b32 v106, 16, v173
  v_and_b32 v107, 0xffff0000, v173
  v_lshlrev_b32 v108, 16, v174
  v_and_b32 v109, 0xffff0000, v174
  v_lshlrev_b32 v110, 16, v175
  v_and_b32 v111, 0xffff0000, v175
  v_lshlrev_b32 v112, 16, v176
  v_and_b32 v113, 0xffff0000, v176
  v_lshlrev_b32 v114, 16, v177
  v_and_b32 v115, 0xffff0000, v177
  v_pk_mul_f32 v[96:97], v[96:97], v[16:17]
  v_pk_mul_f32 v[98:99], v[98:99], v[18:19]
  v_pk_mul_f32 v[100:101], v[100:101], v[32:33]
  v_pk_mul_f32 v[102:103], v[102:103], v[34:35]
  v_pk_mul_f32 v[104:105], v[104:105], v[48:49]
  v_pk_mul_f32 v[106:107], v[106:107], v[50:51]
  v_pk_mul_f32 v[108:109], v[108:109], v[64:65]
  v_pk_mul_f32 v[110:111], v[110:111], v[66:67]
  v_pk_mul_f32 v[112:113], v[112:113], v[80:81]
  v_pk_mul_f32 v[114:115], v[114:115], v[82:83]
  v_cvt_pk_bf16_f32 v16, v96, v97
  v_cvt_pk_bf16_f32 v18, v98, v99
  v_cvt_pk_bf16_f32 v32, v100, v101
  v_cvt_pk_bf16_f32 v34, v102, v103
  v_cvt_pk_bf16_f32 v48, v104, v105
  v_cvt_pk_bf16_f32 v50, v106, v107
  v_cvt_pk_bf16_f32 v64, v108, v109
  v_cvt_pk_bf16_f32 v66, v110, v111
  v_cvt_pk_bf16_f32 v80, v112, v113
  v_cvt_pk_bf16_f32 v82, v114, v115
  v_lshlrev_b32 v96, 16, v16
  v_and_b32 v97, 0xffff0000, v16
  v_lshlrev_b32 v98, 16, v18
  v_and_b32 v99, 0xffff0000, v18
  v_lshlrev_b32 v100, 16, v32
  v_and_b32 v101, 0xffff0000, v32
  v_lshlrev_b32 v102, 16, v34
  v_and_b32 v103, 0xffff0000, v34
  v_lshlrev_b32 v104, 16, v48
  v_and_b32 v105, 0xffff0000, v48
  v_lshlrev_b32 v106, 16, v50
  v_and_b32 v107, 0xffff0000, v50
  v_lshlrev_b32 v108, 16, v64
  v_and_b32 v109, 0xffff0000, v64
  v_lshlrev_b32 v110, 16, v66
  v_and_b32 v111, 0xffff0000, v66
  v_lshlrev_b32 v112, 16, v80
  v_and_b32 v113, 0xffff0000, v80
  v_lshlrev_b32 v114, 16, v82
  v_and_b32 v115, 0xffff0000, v82
  v_pk_add_f32 v[96:97], v[96:97], v[116:117]
  v_pk_add_f32 v[98:99], v[98:99], v[118:119]
  v_pk_add_f32 v[100:101], v[100:101], v[120:121]
  v_pk_add_f32 v[102:103], v[102:103], v[122:123]
  v_pk_add_f32 v[104:105], v[104:105], v[124:125]
  v_pk_add_f32 v[106:107], v[106:107], v[126:127]
  v_pk_add_f32 v[108:109], v[108:109], v[128:129]
  v_pk_add_f32 v[110:111], v[110:111], v[130:131]
  v_pk_add_f32 v[112:113], v[112:113], v[132:133]
  v_pk_add_f32 v[114:115], v[114:115], v[134:135]
  v_cvt_pk_bf16_f32 v240, v96, v97
  v_cvt_pk_bf16_f32 v241, v98, v99
  v_cvt_pk_bf16_f32 v242, v100, v101
  v_cvt_pk_bf16_f32 v243, v102, v103
  v_cvt_pk_bf16_f32 v244, v104, v105
  v_cvt_pk_bf16_f32 v245, v106, v107
  v_cvt_pk_bf16_f32 v246, v108, v109
  v_cvt_pk_bf16_f32 v247, v110, v111
  v_cvt_pk_bf16_f32 v248, v112, v113
  v_cvt_pk_bf16_f32 v249, v114, v115
  buffer_store_dwordx2 v[240:241], v13, s[64:67], 0 offen offset:0
  buffer_store_dwordx2 v[242:243], v13, s[64:67], 0 offen offset:32
  buffer_store_dwordx2 v[244:245], v13, s[64:67], 0 offen offset:64
  buffer_store_dwordx2 v[246:247], v13, s[64:67], 0 offen offset:96
  buffer_store_dwordx2 v[248:249], v13, s[64:67], 0 offen offset:128
  s_endpgm

code_end:
.section .rodata,"a"
.p2align 6
.amdhsa_kernel l1_kernel
  .amdhsa_next_free_vgpr 256
  .amdhsa_next_free_sgpr 102
  .amdhsa_accum_offset 256
  .amdhsa_group_segment_fixed_size 0
  .amdhsa_kernarg_size 128
  .amdhsa_user_sgpr_count 2
  .amdhsa_user_sgpr_kernarg_segment_ptr 1
  .amdhsa_system_sgpr_workgroup_id_x 1
.end_amdhsa_kernel

.p2align 6
.amdhsa_kernel l2_kernel
  .amdhsa_next_free_vgpr 256
  .amdhsa_next_free_sgpr 102
  .amdhsa_accum_offset 256
  .amdhsa_group_segment_fixed_size 0
  .amdhsa_kernarg_size 128
  .amdhsa_user_sgpr_count 2
  .amdhsa_user_sgpr_kernarg_segment_ptr 1
  .amdhsa_system_sgpr_workgroup_id_x 1
.end_amdhsa_kernel
```
